```python
import torch

def _softmax(x, axis=-1):
    return torch.softmax(x, dim=axis)
def _gelu(x):
    return torch.nn.functional.gelu(x, approximate="tanh")
def _silu(x):
    return torch.nn.functional.silu(x)
def _sigmoid(x):
    return torch.sigmoid(x)
def _layernorm(x, axis=-1, eps=1e-5):
    m = x.mean(dim=axis, keepdim=True)
    v = x.var(dim=axis, keepdim=True, unbiased=False)
    return (x - m) / torch.sqrt(v + eps)
def _scatter_add(tgt, idx, src, axis=0):
    return tgt.clone().index_add_(axis, idx, src)
def _segment_sum(src, seg, n):
    out = torch.zeros((n,) + src.shape[1:], dtype=src.dtype)
    return out.index_add_(0, seg, src)
def _pad(x, pw):
    flat = tuple(v for pair in reversed(pw) for v in pair)
    return torch.nn.functional.pad(x, flat)

kernel_name = 'gated_mix__softmax_full_mha__spectral_fnet__prompt'

def setup_inputs():

    _w = (lambda a: (lambda t: t.to(torch.bfloat16) if t.is_floating_point() else t)(torch.as_tensor(a)))
    def _A_setup():
        B, S, D = 1, 2048, 512
        return {
            "x": _w((lambda *s: torch.randn(*s, dtype=torch.bfloat16) * 0.05)(B, S, D)),
            "wqkv": _w((lambda *s: torch.randn(*s, dtype=torch.bfloat16) * 1.6)(D, 3 * D)),
            "wo": _w((lambda *s: torch.randn(*s, dtype=torch.bfloat16) * 1.6)(D, D)),
        }
    _A_in = _A_setup()

    def _B_setup():
        B, S, D = 1, 2048, 512
        ns = torch.arange(S)[:, None] * torch.arange(S)[None, :]
        nd = torch.arange(D)[:, None] * torch.arange(D)[None, :]
        Ws_re = torch.cos(-2.0 * torch.pi * ns / S).to(float)
        Ws_im = torch.sin(-2.0 * torch.pi * ns / S).to(float)
        Wd_re = torch.cos(-2.0 * torch.pi * nd / D).to(float)
        Wd_im = torch.sin(-2.0 * torch.pi * nd / D).to(float)
        return {
            "x": _w((lambda *s: torch.randn(*s, dtype=torch.bfloat16) * 0.05)(B, S, D)),
            "dft_seq_re": _w(Ws_re),
            "dft_seq_im": _w(Ws_im),
            "dft_hid_re": _w(Wd_re),
            "dft_hid_im": _w(Wd_im),
        }
    _B_in = _B_setup()

    return {
        "A_x": _A_in["x"],
        "A_wqkv": _A_in["wqkv"],
        "A_wo": _A_in["wo"],
        "B_x": _B_in["x"],
        "B_dft_seq_re": _B_in["dft_seq_re"],
        "B_dft_seq_im": _B_in["dft_seq_im"],
        "B_dft_hid_re": _B_in["dft_hid_re"],
        "B_dft_hid_im": _B_in["dft_hid_im"],
        "gate_w": _w((lambda *s: torch.randn(*s, dtype=torch.bfloat16) * 0.05)(512) * 16.0),
    }

def reference(A_x, A_wqkv, A_wo, B_x, B_dft_seq_re, B_dft_seq_im, B_dft_hid_re, B_dft_hid_im, gate_w):
    def _A_ref(x, wqkv, wo):
        B, S, D = x.shape
        H = 32; Dh = D // H
        qkv = (lambda x, *d: x.permute(*d))((x @ wqkv).reshape(B, S, 3, H, Dh), 2, 0, 3, 1, 4)
        q, k, v = qkv[0], qkv[1], qkv[2]
        scale = Dh ** -0.5
        scores = torch.einsum("bhqd,bhkd->bhqk", q, k) * scale
        p = _softmax(scores, axis=-1)
        o = torch.einsum("bhqk,bhkd->bhqd", p, v)
        return (lambda x, *d: x.permute(*d))(o, 0, 2, 1, 3).reshape(B, S, D) @ wo

    def _B_ref(x, dft_seq_re, dft_seq_im, dft_hid_re, dft_hid_im):
        a = torch.einsum("bsd,ed->bse", x, dft_hid_re)
        b = torch.einsum("bsd,ed->bse", x, dft_hid_im)
        y = torch.einsum("ts,bse->bte", dft_seq_re, a) - torch.einsum("ts,bse->bte", dft_seq_im, b)
        return y

    x = A_x
    g = _sigmoid((x * gate_w).sum(-1, keepdims=True))
    a = _A_ref(x, A_wqkv, A_wo)
    b = _B_ref(x, B_dft_seq_re, B_dft_seq_im, B_dft_hid_re, B_dft_hid_im)
    return g * a + (1 - g) * b
```

```asm
; @launch grid=(256,1,1) block=(768,1,1) lds=163840
.amdgcn_target "amdgcn-amd-amdhsa--gfx950"
.text
.globl gated_mix__softmax_full_mha__spectral_fnet__prompt_kernel
.p2align 8
.type gated_mix__softmax_full_mha__spectral_fnet__prompt_kernel,@function
gated_mix__softmax_full_mha__spectral_fnet__prompt_kernel:
    s_cmp_ge_u32 s2, 256
    s_cbranch_scc1 K2_END
    s_load_dwordx2 s[86:87], s[0:1], 80
    s_load_dwordx4 s[24:27], s[0:1], 0
    s_load_dwordx4 s[28:31], s[0:1], 48
    s_load_dwordx2 s[32:33], s[0:1], 64
    s_load_dwordx2 s[34:35], s[0:1], 88
    v_lshrrev_b32 v1, 6, v0
    v_and_b32 v0, 63, v0
    v_readfirstlane_b32 s36, v1
    s_and_b32 s38, s2, 7
    s_lshr_b32 s40, s2, 3
    s_and_b32 s39, s40, 1
    s_and_b32 s37, s38, 6
    s_bfe_u32 s41, s40, 0x10001
    s_add_u32 s37, s37, s41
    s_lshr_b32 s40, s40, 2
    s_and_b32 s38, s38, 1
    s_lshl_b32 s38, s38, 3
    s_add_u32 s40, s40, s38
    s_waitcnt lgkmcnt(0)
    s_mov_b32 s16, s34
    s_and_b32 s17, s35, 0xffff
    s_mov_b32 s18, 0x1000000
    s_mov_b32 s19, 0x20000
    s_cmp_ge_u32 s36, 8
    s_cbranch_scc1 K1_LOADER
    s_cmp_ge_u32 s36, 4
    s_cbranch_scc0 K1_COMPUTE
    s_barrier
    s_barrier
    s_barrier
    s_barrier
    s_barrier
    s_barrier
    s_barrier
    s_barrier
    s_branch P1_END
K1_COMPUTE:
    s_lshr_b32 s42, s36, 1
    s_and_b32 s43, s36, 1
    v_and_b32 v8, 31, v0
    v_lshrrev_b32 v9, 5, v0
    v_bfe_u32 v10, v0, 1, 3
    v_xor_b32 v10, v10, v9
    v_lshlrev_b32 v10, 4, v10
    s_lshl_b32 s44, s42, 13
    v_lshlrev_b32 v11, 7, v8
    v_add3_u32 v2, v11, v10, s44
    v_xor_b32 v3, 32, v2
    v_xor_b32 v4, 64, v2
    v_xor_b32 v5, 0x60, v2
    v_bfe_u32 v10, v0, 2, 2
    v_lshl_add_u32 v11, v9, 3, v10
    v_lshlrev_b32 v11, 7, v11
    v_bfe_u32 v12, v0, 4, 1
    v_bfe_u32 v13, v0, 1, 1
    v_lshl_add_u32 v12, v12, 1, v13
    v_bfe_u32 v13, v0, 3, 1
    v_lshlrev_b32 v13, 2, v13
    v_xor_b32 v12, v12, v13
    v_lshlrev_b32 v12, 4, v12
    v_and_b32 v13, 1, v0
    v_lshlrev_b32 v13, 3, v13
    v_add3_u32 v11, v11, v12, v13
    s_lshl_b32 s44, s43, 13
    s_add_u32 s44, s44, 16384
    v_add_u32 v6, s44, v11
    v_xor_b32 v7, 64, v6
    v_mov_b32 v64, 0
    v_mov_b32 v65, 0
    v_mov_b32 v66, 0
    v_mov_b32 v67, 0
    v_mov_b32 v68, 0
    v_mov_b32 v69, 0
    v_mov_b32 v70, 0
    v_mov_b32 v71, 0
    v_mov_b32 v72, 0
    v_mov_b32 v73, 0
    v_mov_b32 v74, 0
    v_mov_b32 v75, 0
    v_mov_b32 v76, 0
    v_mov_b32 v77, 0
    v_mov_b32 v78, 0
    v_mov_b32 v79, 0
    v_mov_b32 v80, 0
    v_mov_b32 v81, 0
    v_mov_b32 v82, 0
    v_mov_b32 v83, 0
    v_mov_b32 v84, 0
    v_mov_b32 v85, 0
    v_mov_b32 v86, 0
    v_mov_b32 v87, 0
    v_mov_b32 v88, 0
    v_mov_b32 v89, 0
    v_mov_b32 v90, 0
    v_mov_b32 v91, 0
    v_mov_b32 v92, 0
    v_mov_b32 v93, 0
    v_mov_b32 v94, 0
    v_mov_b32 v95, 0
    v_mov_b32 v96, 0
    v_mov_b32 v97, 0
    v_mov_b32 v98, 0
    v_mov_b32 v99, 0
    v_mov_b32 v100, 0
    v_mov_b32 v101, 0
    v_mov_b32 v102, 0
    v_mov_b32 v103, 0
    v_mov_b32 v104, 0
    v_mov_b32 v105, 0
    v_mov_b32 v106, 0
    v_mov_b32 v107, 0
    v_mov_b32 v108, 0
    v_mov_b32 v109, 0
    v_mov_b32 v110, 0
    v_mov_b32 v111, 0
    v_mov_b32 v112, 0
    v_mov_b32 v113, 0
    v_mov_b32 v114, 0
    v_mov_b32 v115, 0
    v_mov_b32 v116, 0
    v_mov_b32 v117, 0
    v_mov_b32 v118, 0
    v_mov_b32 v119, 0
    v_mov_b32 v120, 0
    v_mov_b32 v121, 0
    v_mov_b32 v122, 0
    v_mov_b32 v123, 0
    v_mov_b32 v124, 0
    v_mov_b32 v125, 0
    v_mov_b32 v126, 0
    v_mov_b32 v127, 0
    s_barrier
    ds_read_b128 v[16:19], v2
    ds_read_b128 v[20:23], v2 offset:4096
    ds_read_b64_tr_b16 v[24:25], v6 offset:0
    ds_read_b64_tr_b16 v[26:27], v6 offset:512
    ds_read_b64_tr_b16 v[28:29], v7 offset:0
    ds_read_b64_tr_b16 v[30:31], v7 offset:512
    s_mov_b32 s45, 0
    s_cmp_eq_u32 s43, 0
    s_cbranch_scc0 K1_LOOP1
.p2align 6
K1_LOOP0:
    s_waitcnt lgkmcnt(0)
    v_mfma_f32_32x32x16_bf16 v[64:79], v[24:27], v[16:19], v[64:79]
    ds_read_b128 v[32:35], v3
    ds_read_b128 v[36:39], v3 offset:4096
    ds_read_b64_tr_b16 v[40:41], v6 offset:2048
    v_mfma_f32_32x32x16_bf16 v[80:95], v[28:31], v[16:19], v[80:95]
    ds_read_b64_tr_b16 v[42:43], v6 offset:2560
    ds_read_b64_tr_b16 v[44:45], v7 offset:2048
    ds_read_b64_tr_b16 v[46:47], v7 offset:2560
    v_mfma_f32_32x32x16_bf16 v[96:111], v[24:27], v[20:23], v[96:111]
    v_mfma_f32_32x32x16_bf16 v[112:127], v[28:31], v[20:23], v[112:127]
    s_waitcnt lgkmcnt(0)
    v_mfma_f32_32x32x16_bf16 v[64:79], v[40:43], v[32:35], v[64:79]
    ds_read_b128 v[16:19], v4
    ds_read_b128 v[20:23], v4 offset:4096
    ds_read_b64_tr_b16 v[24:25], v6 offset:4096
    v_mfma_f32_32x32x16_bf16 v[80:95], v[44:47], v[32:35], v[80:95]
    ds_read_b64_tr_b16 v[26:27], v6 offset:4608
    ds_read_b64_tr_b16 v[28:29], v7 offset:4096
    ds_read_b64_tr_b16 v[30:31], v7 offset:4608
    v_mfma_f32_32x32x16_bf16 v[96:111], v[40:43], v[36:39], v[96:111]
    v_mfma_f32_32x32x16_bf16 v[112:127], v[44:47], v[36:39], v[112:127]
    s_waitcnt lgkmcnt(0)
    v_mfma_f32_32x32x16_bf16 v[64:79], v[24:27], v[16:19], v[64:79]
    ds_read_b128 v[32:35], v5
    ds_read_b128 v[36:39], v5 offset:4096
    ds_read_b64_tr_b16 v[40:41], v6 offset:6144
    v_mfma_f32_32x32x16_bf16 v[80:95], v[28:31], v[16:19], v[80:95]
    ds_read_b64_tr_b16 v[42:43], v6 offset:6656
    ds_read_b64_tr_b16 v[44:45], v7 offset:6144
    ds_read_b64_tr_b16 v[46:47], v7 offset:6656
    v_mfma_f32_32x32x16_bf16 v[96:111], v[24:27], v[20:23], v[96:111]
    v_mfma_f32_32x32x16_bf16 v[112:127], v[28:31], v[20:23], v[112:127]
    s_waitcnt lgkmcnt(0)
    s_mov_b32 s46, 0x8000
    s_cmp_eq_u32 s45, 4
    s_cselect_b32 s46, 0xfffe0000, s46
    v_add_u32 v2, s46, v2
    v_add_u32 v3, s46, v3
    v_add_u32 v4, s46, v4
    v_add_u32 v5, s46, v5
    v_add_u32 v6, s46, v6
    v_add_u32 v7, s46, v7
    s_cmp_eq_u32 s45, 7
    s_cbranch_scc1 K1_NOBAR0
    s_barrier
K1_NOBAR0:
    v_mfma_f32_32x32x16_bf16 v[64:79], v[40:43], v[32:35], v[64:79]
    ds_read_b128 v[16:19], v2
    ds_read_b128 v[20:23], v2 offset:4096
    ds_read_b64_tr_b16 v[24:25], v6 offset:0
    v_mfma_f32_32x32x16_bf16 v[80:95], v[44:47], v[32:35], v[80:95]
    ds_read_b64_tr_b16 v[26:27], v6 offset:512
    ds_read_b64_tr_b16 v[28:29], v7 offset:0
    ds_read_b64_tr_b16 v[30:31], v7 offset:512
    v_mfma_f32_32x32x16_bf16 v[96:111], v[40:43], v[36:39], v[96:111]
    v_mfma_f32_32x32x16_bf16 v[112:127], v[44:47], v[36:39], v[112:127]
    s_add_u32 s45, s45, 1
    s_cmp_lt_u32 s45, 8
    s_cbranch_scc1 K1_LOOP0
    s_branch K1_EPI_QK
.p2align 6
K1_LOOP1:
    s_waitcnt lgkmcnt(0)
    v_mfma_f32_32x32x16_bf16 v[64:79], v[16:19], v[24:27], v[64:79]
    ds_read_b128 v[32:35], v3
    ds_read_b128 v[36:39], v3 offset:4096
    ds_read_b64_tr_b16 v[40:41], v6 offset:2048
    v_mfma_f32_32x32x16_bf16 v[80:95], v[16:19], v[28:31], v[80:95]
    ds_read_b64_tr_b16 v[42:43], v6 offset:2560
    ds_read_b64_tr_b16 v[44:45], v7 offset:2048
    ds_read_b64_tr_b16 v[46:47], v7 offset:2560
    v_mfma_f32_32x32x16_bf16 v[96:111], v[20:23], v[24:27], v[96:111]
    v_mfma_f32_32x32x16_bf16 v[112:127], v[20:23], v[28:31], v[112:127]
    s_waitcnt lgkmcnt(0)
    v_mfma_f32_32x32x16_bf16 v[64:79], v[32:35], v[40:43], v[64:79]
    ds_read_b128 v[16:19], v4
    ds_read_b128 v[20:23], v4 offset:4096
    ds_read_b64_tr_b16 v[24:25], v6 offset:4096
    v_mfma_f32_32x32x16_bf16 v[80:95], v[32:35], v[44:47], v[80:95]
    ds_read_b64_tr_b16 v[26:27], v6 offset:4608
    ds_read_b64_tr_b16 v[28:29], v7 offset:4096
    ds_read_b64_tr_b16 v[30:31], v7 offset:4608
    v_mfma_f32_32x32x16_bf16 v[96:111], v[36:39], v[40:43], v[96:111]
    v_mfma_f32_32x32x16_bf16 v[112:127], v[36:39], v[44:47], v[112:127]
    s_waitcnt lgkmcnt(0)
    v_mfma_f32_32x32x16_bf16 v[64:79], v[16:19], v[24:27], v[64:79]
    ds_read_b128 v[32:35], v5
    ds_read_b128 v[36:39], v5 offset:4096
    ds_read_b64_tr_b16 v[40:41], v6 offset:6144
    v_mfma_f32_32x32x16_bf16 v[80:95], v[16:19], v[28:31], v[80:95]
    ds_read_b64_tr_b16 v[42:43], v6 offset:6656
    ds_read_b64_tr_b16 v[44:45], v7 offset:6144
    ds_read_b64_tr_b16 v[46:47], v7 offset:6656
    v_mfma_f32_32x32x16_bf16 v[96:111], v[20:23], v[24:27], v[96:111]
    v_mfma_f32_32x32x16_bf16 v[112:127], v[20:23], v[28:31], v[112:127]
    s_waitcnt lgkmcnt(0)
    s_mov_b32 s46, 0x8000
    s_cmp_eq_u32 s45, 4
    s_cselect_b32 s46, 0xfffe0000, s46
    v_add_u32 v2, s46, v2
    v_add_u32 v3, s46, v3
    v_add_u32 v4, s46, v4
    v_add_u32 v5, s46, v5
    v_add_u32 v6, s46, v6
    v_add_u32 v7, s46, v7
    s_cmp_eq_u32 s45, 7
    s_cbranch_scc1 K1_NOBAR1
    s_barrier
K1_NOBAR1:
    v_mfma_f32_32x32x16_bf16 v[64:79], v[32:35], v[40:43], v[64:79]
    ds_read_b128 v[16:19], v2
    ds_read_b128 v[20:23], v2 offset:4096
    ds_read_b64_tr_b16 v[24:25], v6 offset:0
    v_mfma_f32_32x32x16_bf16 v[80:95], v[32:35], v[44:47], v[80:95]
    ds_read_b64_tr_b16 v[26:27], v6 offset:512
    ds_read_b64_tr_b16 v[28:29], v7 offset:0
    ds_read_b64_tr_b16 v[30:31], v7 offset:512
    v_mfma_f32_32x32x16_bf16 v[96:111], v[36:39], v[40:43], v[96:111]
    v_mfma_f32_32x32x16_bf16 v[112:127], v[36:39], v[44:47], v[112:127]
    s_add_u32 s45, s45, 1
    s_cmp_lt_u32 s45, 8
    s_cbranch_scc1 K1_LOOP1
    s_cmp_eq_u32 s39, 0
    s_cbranch_scc0 K1_EPI_F
    s_waitcnt lgkmcnt(0)
    v_and_b32 v8, 15, v0
    v_lshlrev_b32 v8, 4, v8
    v_bfe_u32 v9, v0, 4, 1
    v_lshlrev_b32 v9, 16, v9
    v_lshrrev_b32 v10, 5, v0
    v_lshlrev_b32 v10, 8, v10
    v_add3_u32 v8, v8, v9, v10
    s_lshl_b32 s46, s37, 18
    s_lshl_b32 s47, s40, 2
    s_lshl_b32 s48, s42, 1
    s_add_u32 s47, s47, s48
    s_lshl_b32 s47, s47, 10
    s_add_u32 s46, s46, s47
    s_add_u32 s46, s46, 0x400000
    s_nop 7
    v_cvt_pk_bf16_f32 v16, v64, v65
    v_cvt_pk_bf16_f32 v17, v66, v67
    v_cvt_pk_bf16_f32 v18, v68, v69
    v_cvt_pk_bf16_f32 v19, v70, v71
    s_add_u32 s47, s46, 0
    buffer_store_dwordx4 v[16:19], v8, s[16:19], s47 offen offset:0 sc1
    v_cvt_pk_bf16_f32 v20, v72, v73
    v_cvt_pk_bf16_f32 v21, v74, v75
    v_cvt_pk_bf16_f32 v22, v76, v77
    v_cvt_pk_bf16_f32 v23, v78, v79
    s_add_u32 s47, s46, 0
    buffer_store_dwordx4 v[20:23], v8, s[16:19], s47 offen offset:512 sc1
    v_cvt_pk_bf16_f32 v24, v80, v81
    v_cvt_pk_bf16_f32 v25, v82, v83
    v_cvt_pk_bf16_f32 v26, v84, v85
    v_cvt_pk_bf16_f32 v27, v86, v87
    s_add_u32 s47, s46, 131072
    buffer_store_dwordx4 v[24:27], v8, s[16:19], s47 offen offset:0 sc1
    v_cvt_pk_bf16_f32 v28, v88, v89
    v_cvt_pk_bf16_f32 v29, v90, v91
    v_cvt_pk_bf16_f32 v30, v92, v93
    v_cvt_pk_bf16_f32 v31, v94, v95
    s_add_u32 s47, s46, 131072
    buffer_store_dwordx4 v[28:31], v8, s[16:19], s47 offen offset:512 sc1
    v_cvt_pk_bf16_f32 v32, v96, v97
    v_cvt_pk_bf16_f32 v33, v98, v99
    v_cvt_pk_bf16_f32 v34, v100, v101
    v_cvt_pk_bf16_f32 v35, v102, v103
    s_add_u32 s47, s46, 1024
    buffer_store_dwordx4 v[32:35], v8, s[16:19], s47 offen offset:0 sc1
    v_cvt_pk_bf16_f32 v36, v104, v105
    v_cvt_pk_bf16_f32 v37, v106, v107
    v_cvt_pk_bf16_f32 v38, v108, v109
    v_cvt_pk_bf16_f32 v39, v110, v111
    s_add_u32 s47, s46, 1024
    buffer_store_dwordx4 v[36:39], v8, s[16:19], s47 offen offset:512 sc1
    v_cvt_pk_bf16_f32 v40, v112, v113
    v_cvt_pk_bf16_f32 v41, v114, v115
    v_cvt_pk_bf16_f32 v42, v116, v117
    v_cvt_pk_bf16_f32 v43, v118, v119
    s_add_u32 s47, s46, 132096
    buffer_store_dwordx4 v[40:43], v8, s[16:19], s47 offen offset:0 sc1
    v_cvt_pk_bf16_f32 v44, v120, v121
    v_cvt_pk_bf16_f32 v45, v122, v123
    v_cvt_pk_bf16_f32 v46, v124, v125
    v_cvt_pk_bf16_f32 v47, v126, v127
    s_add_u32 s47, s46, 132096
    buffer_store_dwordx4 v[44:47], v8, s[16:19], s47 offen offset:512 sc1
    s_branch P1_END
K1_EPI_F:
    s_waitcnt lgkmcnt(0)
    s_cmp_lt_u32 s37, 4
    s_cselect_b32 s46, 1.0, -1.0
    s_mov_b32 s48, 0x6a0000
    s_cselect_b32 s47, 0x600000, s48
    s_and_b32 s48, s37, 3
    s_lshl_b32 s48, s48, 17
    s_add_u32 s47, s47, s48
    s_lshl_b32 s48, s40, 2
    s_lshl_b32 s49, s42, 1
    s_add_u32 s48, s48, s49
    s_lshl_b32 s49, s48, 10
    s_add_u32 s47, s47, s49
    v_lshlrev_b32 v8, 4, v0
    s_nop 4
    s_cmp_eq_u32 s48, 0
    s_cbranch_scc0 K1_EPI_F2
    s_cmp_lt_u32 s37, 4
    s_cbranch_scc0 K1_EPI_F2
    s_mov_b32 exec_lo, -1
    s_mov_b32 exec_hi, 0
    v_lshlrev_b32 v9, 2, v0
    s_lshl_b32 s49, s37, 8
    s_add_u32 s49, s49, 0x720000
    buffer_store_dword v96, v9, s[16:19], s49 offen offset:0 sc1
    buffer_store_dword v112, v9, s[16:19], s49 offen offset:128 sc1
    s_nop 1
    v_mov_b32 v96, 0
    v_mov_b32 v112, 0
    s_mov_b64 exec, -1
K1_EPI_F2:
    v_fma_f32 v64, v96, s46, v64
    v_fma_f32 v65, v97, s46, v65
    v_fma_f32 v66, v98, s46, v66
    v_fma_f32 v67, v99, s46, v67
    v_fma_f32 v68, v100, s46, v68
    v_fma_f32 v69, v101, s46, v69
    v_fma_f32 v70, v102, s46, v70
    v_fma_f32 v71, v103, s46, v71
    v_fma_f32 v72, v104, s46, v72
    v_fma_f32 v73, v105, s46, v73
    v_fma_f32 v74, v106, s46, v74
    v_fma_f32 v75, v107, s46, v75
    v_fma_f32 v76, v108, s46, v76
    v_fma_f32 v77, v109, s46, v77
    v_fma_f32 v78, v110, s46, v78
    v_fma_f32 v79, v111, s46, v79
    v_cvt_pk_bf16_f32 v16, v64, v65
    v_cvt_pk_bf16_f32 v17, v66, v67
    v_cvt_pk_bf16_f32 v18, v68, v69
    v_cvt_pk_bf16_f32 v19, v70, v71
    s_add_u32 s49, s47, 0
    buffer_store_dwordx4 v[16:19], v8, s[16:19], s49 offen offset:0 sc1
    v_cvt_pk_bf16_f32 v20, v72, v73
    v_cvt_pk_bf16_f32 v21, v74, v75
    v_cvt_pk_bf16_f32 v22, v76, v77
    v_cvt_pk_bf16_f32 v23, v78, v79
    s_add_u32 s49, s47, 0
    buffer_store_dwordx4 v[20:23], v8, s[16:19], s49 offen offset:1024 sc1
    v_fma_f32 v80, v112, s46, v80
    v_fma_f32 v81, v113, s46, v81
    v_fma_f32 v82, v114, s46, v82
    v_fma_f32 v83, v115, s46, v83
    v_fma_f32 v84, v116, s46, v84
    v_fma_f32 v85, v117, s46, v85
    v_fma_f32 v86, v118, s46, v86
    v_fma_f32 v87, v119, s46, v87
    v_fma_f32 v88, v120, s46, v88
    v_fma_f32 v89, v121, s46, v89
    v_fma_f32 v90, v122, s46, v90
    v_fma_f32 v91, v123, s46, v91
    v_fma_f32 v92, v124, s46, v92
    v_fma_f32 v93, v125, s46, v93
    v_fma_f32 v94, v126, s46, v94
    v_fma_f32 v95, v127, s46, v95
    v_cvt_pk_bf16_f32 v24, v80, v81
    v_cvt_pk_bf16_f32 v25, v82, v83
    v_cvt_pk_bf16_f32 v26, v84, v85
    v_cvt_pk_bf16_f32 v27, v86, v87
    s_add_u32 s49, s47, 65536
    buffer_store_dwordx4 v[24:27], v8, s[16:19], s49 offen offset:0 sc1
    v_cvt_pk_bf16_f32 v28, v88, v89
    v_cvt_pk_bf16_f32 v29, v90, v91
    v_cvt_pk_bf16_f32 v30, v92, v93
    v_cvt_pk_bf16_f32 v31, v94, v95
    s_add_u32 s49, s47, 65536
    buffer_store_dwordx4 v[28:31], v8, s[16:19], s49 offen offset:1024 sc1
    s_branch P1_END
K1_EPI_QK:
    s_waitcnt lgkmcnt(0)
    s_cmp_eq_u32 s39, 0
    s_cselect_b32 s46, 1.0, 0x3eb8aa3b
    s_cselect_b32 s47, 0x200000, 0
    s_lshl_b32 s48, s37, 18
    s_add_u32 s47, s47, s48
    s_lshl_b32 s48, s40, 2
    s_lshl_b32 s49, s42, 1
    s_add_u32 s48, s48, s49
    s_lshl_b32 s48, s48, 10
    s_add_u32 s47, s47, s48
    v_lshlrev_b32 v8, 4, v0
    s_nop 7
    v_mul_f32 v64, s46, v64
    v_mul_f32 v65, s46, v65
    v_mul_f32 v66, s46, v66
    v_mul_f32 v67, s46, v67
    v_mul_f32 v68, s46, v68
    v_mul_f32 v69, s46, v69
    v_mul_f32 v70, s46, v70
    v_mul_f32 v71, s46, v71
    v_cvt_pk_bf16_f32 v16, v64, v65
    v_cvt_pk_bf16_f32 v17, v66, v67
    v_cvt_pk_bf16_f32 v18, v68, v69
    v_cvt_pk_bf16_f32 v19, v70, v71
    s_add_u32 s49, s47, 0
    buffer_store_dwordx4 v[16:19], v8, s[16:19], s49 offen sc1
    v_mul_f32 v72, s46, v72
    v_mul_f32 v73, s46, v73
    v_mul_f32 v74, s46, v74
    v_mul_f32 v75, s46, v75
    v_mul_f32 v76, s46, v76
    v_mul_f32 v77, s46, v77
    v_mul_f32 v78, s46, v78
    v_mul_f32 v79, s46, v79
    v_cvt_pk_bf16_f32 v20, v72, v73
    v_cvt_pk_bf16_f32 v21, v74, v75
    v_cvt_pk_bf16_f32 v22, v76, v77
    v_cvt_pk_bf16_f32 v23, v78, v79
    s_add_u32 s49, s47, 65536
    buffer_store_dwordx4 v[20:23], v8, s[16:19], s49 offen sc1
    v_mul_f32 v80, s46, v80
    v_mul_f32 v81, s46, v81
    v_mul_f32 v82, s46, v82
    v_mul_f32 v83, s46, v83
    v_mul_f32 v84, s46, v84
    v_mul_f32 v85, s46, v85
    v_mul_f32 v86, s46, v86
    v_mul_f32 v87, s46, v87
    v_cvt_pk_bf16_f32 v24, v80, v81
    v_cvt_pk_bf16_f32 v25, v82, v83
    v_cvt_pk_bf16_f32 v26, v84, v85
    v_cvt_pk_bf16_f32 v27, v86, v87
    s_add_u32 s49, s47, 131072
    buffer_store_dwordx4 v[24:27], v8, s[16:19], s49 offen sc1
    v_mul_f32 v88, s46, v88
    v_mul_f32 v89, s46, v89
    v_mul_f32 v90, s46, v90
    v_mul_f32 v91, s46, v91
    v_mul_f32 v92, s46, v92
    v_mul_f32 v93, s46, v93
    v_mul_f32 v94, s46, v94
    v_mul_f32 v95, s46, v95
    v_cvt_pk_bf16_f32 v28, v88, v89
    v_cvt_pk_bf16_f32 v29, v90, v91
    v_cvt_pk_bf16_f32 v30, v92, v93
    v_cvt_pk_bf16_f32 v31, v94, v95
    s_add_u32 s49, s47, 196608
    buffer_store_dwordx4 v[28:31], v8, s[16:19], s49 offen sc1
    v_mul_f32 v96, s46, v96
    v_mul_f32 v97, s46, v97
    v_mul_f32 v98, s46, v98
    v_mul_f32 v99, s46, v99
    v_mul_f32 v100, s46, v100
    v_mul_f32 v101, s46, v101
    v_mul_f32 v102, s46, v102
    v_mul_f32 v103, s46, v103
    v_cvt_pk_bf16_f32 v32, v96, v97
    v_cvt_pk_bf16_f32 v33, v98, v99
    v_cvt_pk_bf16_f32 v34, v100, v101
    v_cvt_pk_bf16_f32 v35, v102, v103
    s_add_u32 s49, s47, 1024
    buffer_store_dwordx4 v[32:35], v8, s[16:19], s49 offen sc1
    v_mul_f32 v104, s46, v104
    v_mul_f32 v105, s46, v105
    v_mul_f32 v106, s46, v106
    v_mul_f32 v107, s46, v107
    v_mul_f32 v108, s46, v108
    v_mul_f32 v109, s46, v109
    v_mul_f32 v110, s46, v110
    v_mul_f32 v111, s46, v111
    v_cvt_pk_bf16_f32 v36, v104, v105
    v_cvt_pk_bf16_f32 v37, v106, v107
    v_cvt_pk_bf16_f32 v38, v108, v109
    v_cvt_pk_bf16_f32 v39, v110, v111
    s_add_u32 s49, s47, 66560
    buffer_store_dwordx4 v[36:39], v8, s[16:19], s49 offen sc1
    v_mul_f32 v112, s46, v112
    v_mul_f32 v113, s46, v113
    v_mul_f32 v114, s46, v114
    v_mul_f32 v115, s46, v115
    v_mul_f32 v116, s46, v116
    v_mul_f32 v117, s46, v117
    v_mul_f32 v118, s46, v118
    v_mul_f32 v119, s46, v119
    v_cvt_pk_bf16_f32 v40, v112, v113
    v_cvt_pk_bf16_f32 v41, v114, v115
    v_cvt_pk_bf16_f32 v42, v116, v117
    v_cvt_pk_bf16_f32 v43, v118, v119
    s_add_u32 s49, s47, 132096
    buffer_store_dwordx4 v[40:43], v8, s[16:19], s49 offen sc1
    v_mul_f32 v120, s46, v120
    v_mul_f32 v121, s46, v121
    v_mul_f32 v122, s46, v122
    v_mul_f32 v123, s46, v123
    v_mul_f32 v124, s46, v124
    v_mul_f32 v125, s46, v125
    v_mul_f32 v126, s46, v126
    v_mul_f32 v127, s46, v127
    v_cvt_pk_bf16_f32 v44, v120, v121
    v_cvt_pk_bf16_f32 v45, v122, v123
    v_cvt_pk_bf16_f32 v46, v124, v125
    v_cvt_pk_bf16_f32 v47, v126, v127
    s_add_u32 s49, s47, 197632
    buffer_store_dwordx4 v[44:47], v8, s[16:19], s49 offen sc1
    s_branch P1_END
K1_LOADER:
    s_mov_b32 s4, s24
    s_and_b32 s5, s25, 0xffff
    s_mov_b32 s6, 0x200000
    s_mov_b32 s7, 0x20000
    s_mov_b32 s92, s86
    s_and_b32 s93, s87, 0xffff
    s_mov_b32 s94, 0x100
    s_mov_b32 s95, 0x20000
    s_sub_u32 s50, s36, 8
    s_or_b32 s50, s50, s2
    s_cmp_eq_u32 s50, 0
    s_cbranch_scc0 K1_NOEPOCH
    s_memrealtime s[50:51]
    s_waitcnt lgkmcnt(0)
    s_or_b32 s50, s50, 1
    v_mov_b32 v2, s50
    v_mov_b32 v3, 0
    s_mov_b64 exec, 1
    buffer_store_dword v2, v3, s[92:95], 0 offen sc1
    s_mov_b64 exec, -1
K1_NOEPOCH:
    s_sub_u32 s41, s36, 8
    s_lshr_b32 s42, s41, 1
    s_and_b32 s43, s41, 1
    v_lshrrev_b32 v9, 3, v0
    v_lshrrev_b32 v10, 2, v9
    v_lshlrev_b32 v10, 3, v10
    v_and_b32 v11, 3, v9
    s_lshl_b32 s52, s40, 6
    s_lshl_b32 s53, s42, 5
    s_add_u32 s52, s52, s53
    v_add3_u32 v10, v10, v11, s52
    v_and_b32 v11, 7, v0
    v_lshrrev_b32 v12, 1, v9
    v_xor_b32 v12, v11, v12
    s_cmp_eq_u32 s43, 1
    s_cselect_b64 s[68:69], -1, 0
    v_mov_b32 v14, 0x400
    s_lshl_b32 s53, s41, 12
    s_lshr_b32 s66, s2, 3
    s_lshr_b32 s67, s66, 2
    s_and_b32 s66, s66, 3
    s_lshl_b32 s66, s66, 1
    s_add_u32 s66, s66, s67
    s_and_b32 s66, s66, 7
    s_lshl_b32 s55, s66, 7
    v_add_u32 v13, 0, v10
    v_sub_u32 v15, 0x800, v13
    v_cndmask_b32 v13, v13, v15, s[68:69]
    v_cmp_eq_u32 vcc, 0x800, v13
    s_nop 1
    v_cndmask_b32 v13, v13, v14, vcc
    v_lshlrev_b32 v13, 10, v13
    v_lshl_add_u32 v2, v12, 4, v13
    s_add_u32 m0, s53, 0
    s_nop 0
    buffer_load_dwordx4 v2, s[4:7], s55 offen lds
    v_add_u32 v13, 4, v10
    v_sub_u32 v15, 0x800, v13
    v_cndmask_b32 v13, v13, v15, s[68:69]
    v_lshlrev_b32 v13, 10, v13
    v_xor_b32 v15, 4, v12
    v_lshl_add_u32 v3, v15, 4, v13
    s_add_u32 m0, s53, 1024
    s_nop 0
    buffer_load_dwordx4 v3, s[4:7], s55 offen lds
    v_add_u32 v13, 16, v10
    v_sub_u32 v15, 0x800, v13
    v_cndmask_b32 v13, v13, v15, s[68:69]
    v_lshlrev_b32 v13, 10, v13
    v_lshl_add_u32 v4, v12, 4, v13
    s_add_u32 m0, s53, 2048
    s_nop 0
    buffer_load_dwordx4 v4, s[4:7], s55 offen lds
    v_add_u32 v13, 20, v10
    v_sub_u32 v15, 0x800, v13
    v_cndmask_b32 v13, v13, v15, s[68:69]
    v_lshlrev_b32 v13, 10, v13
    v_xor_b32 v15, 4, v12
    v_lshl_add_u32 v5, v15, 4, v13
    s_add_u32 m0, s53, 3072
    s_nop 0
    buffer_load_dwordx4 v5, s[4:7], s55 offen lds
    s_mov_b32 s8, s26
    s_and_b32 s9, s27, 0xffff
    s_mov_b32 s10, 0x180000
    s_mov_b32 s11, 0x20000
    s_mov_b32 s20, s32
    s_and_b32 s21, s33, 0xffff
    s_mov_b32 s22, 0x400
    s_mov_b32 s23, 0x20000
    s_cmp_lt_u32 s37, 4
    s_cselect_b32 s44, s28, s30
    s_cselect_b32 s45, s29, s31
    s_lshl_b32 s47, s37, 7
    s_and_b32 s49, s37, 3
    s_lshl_b32 s49, s49, 7
    s_add_u32 s63, s47, 2048
    s_mov_b32 s64, 0x80000
    s_movk_i32 s65, 1024
    s_cmp_eq_u32 s39, 0
    s_cselect_b32 s12, s26, s44
    s_cselect_b32 s13, s27, s45
    s_cselect_b32 s14, 0x180000, s64
    s_mov_b32 s15, 0x20000
    s_cselect_b32 s46, 3072, s65
    s_cselect_b32 s48, s65, 0
    s_cselect_b32 s49, s63, s49
    s_and_b32 s13, s13, 0xffff
    s_add_u32 s48, s48, s47
    v_bfe_u32 v13, v9, 1, 1
    v_lshlrev_b32 v13, 2, v13
    v_xor_b32 v13, v11, v13
    v_lshlrev_b32 v13, 4, v13
    s_lshl_b32 s52, s41, 4
    v_add_u32 v15, s52, v9
    s_movk_i32 s63, 3072
    v_mul_lo_u32 v6, v15, s63
    v_add3_u32 v6, v6, v13, s48
    v_mul_lo_u32 v7, v15, s46
    v_add3_u32 v7, v7, v13, s49
    s_lshl_b32 s54, s41, 11
    s_add_u32 s54, s54, 16384
    s_mov_b32 s52, 0
    s_lshl_b32 s58, s46, 3
    s_lshl_b32 s59, s46, 6
    s_mul_i32 s56, s66, 196608
    s_mul_i32 s57, s66, s59
    s_mov_b32 s62, 0
    s_branch K1_ISSUE_W
K1_ISSUE:
    s_add_u32 s60, s52, s53
    s_add_u32 m0, s60, 0
    s_nop 0
    buffer_load_dwordx4 v2, s[4:7], s55 offen lds
    s_add_u32 m0, s60, 1024
    s_nop 0
    buffer_load_dwordx4 v3, s[4:7], s55 offen lds
    s_add_u32 m0, s60, 2048
    s_nop 0
    buffer_load_dwordx4 v4, s[4:7], s55 offen lds
    s_add_u32 m0, s60, 3072
    s_nop 0
    buffer_load_dwordx4 v5, s[4:7], s55 offen lds
K1_ISSUE_W:
    s_add_u32 s60, s52, s54
    s_mov_b32 m0, s60
    s_add_u32 s61, s56, 24576
    buffer_load_dwordx4 v6, s[8:11], s56 offen lds
    s_add_u32 m0, s60, 1024
    s_nop 0
    buffer_load_dwordx4 v6, s[8:11], s61 offen lds
    s_add_u32 m0, s60, 8192
    s_add_u32 s61, s57, s58
    buffer_load_dwordx4 v7, s[12:15], s57 offen lds
    s_add_u32 m0, s60, 9216
    s_nop 0
    buffer_load_dwordx4 v7, s[12:15], s61 offen lds
    s_add_u32 s52, s52, 0x8000
    s_cmp_eq_u32 s52, 0x28000
    s_cselect_b32 s52, 0, s52
    s_add_u32 s55, s55, 128
    s_add_u32 s56, s56, 196608
    s_add_u32 s57, s57, s59
    s_cmp_eq_u32 s55, 1024
    s_cselect_b32 s55, 0, s55
    s_cselect_b32 s56, 0, s56
    s_cselect_b32 s57, 0, s57
    s_add_u32 s62, s62, 1
    s_bitcmp1_b32 0x2a, s62
    s_cbranch_scc1 K1_ISSUE
    s_cmp_eq_u32 s62, 2
    s_cbranch_scc0 K1_NOT2
    s_waitcnt vmcnt(8)
    s_barrier
    s_branch K1_ISSUE
K1_NOT2:
    s_cmp_eq_u32 s62, 4
    s_cbranch_scc0 K1_NOT4
    s_waitcnt vmcnt(16)
    s_barrier
    s_branch K1_ISSUE
K1_NOT4:
    s_waitcnt vmcnt(24)
    s_barrier
    s_cmp_lt_u32 s62, 8
    s_cbranch_scc1 K1_ISSUE
    s_waitcnt vmcnt(16)
    s_barrier
    s_lshl_b32 s50, s37, 1
    s_add_u32 s50, s50, s39
    s_lshl_b32 s50, s50, 2
    s_add_u32 s50, s50, s41
    s_lshl_b32 s51, s40, 6
    s_add_u32 s50, s50, s51
    s_sub_u32 s51, 2048, s50
    s_cmp_eq_u32 s50, 0
    s_cselect_b32 s51, 1024, s51
    v_lshlrev_b32 v8, 4, v0
    s_lshl_b32 s52, s50, 10
    s_lshl_b32 s53, s51, 10
    buffer_load_dwordx4 v[16:19], v8, s[4:7], s52 offen
    buffer_load_dwordx4 v[20:23], v8, s[4:7], s53 offen
    buffer_load_dwordx4 v[24:27], v8, s[20:23], 0 offen
    s_waitcnt vmcnt(11)
    s_barrier
    s_waitcnt vmcnt(3)
    s_barrier
    s_waitcnt vmcnt(0)
    v_lshlrev_b32 v28, 16, v24
    v_and_b32 v29, 0xffff0000, v24
    v_lshlrev_b32 v30, 16, v25
    v_and_b32 v31, 0xffff0000, v25
    v_lshlrev_b32 v32, 16, v26
    v_and_b32 v33, 0xffff0000, v26
    v_lshlrev_b32 v34, 16, v27
    v_and_b32 v35, 0xffff0000, v27
    v_lshlrev_b32 v36, 16, v16
    v_and_b32 v37, 0xffff0000, v16
    v_mul_f32 v40, v36, v28
    v_sub_f32 v42, v36, v37
    v_fmac_f32 v40, v37, v29
    v_lshlrev_b32 v36, 16, v17
    v_and_b32 v37, 0xffff0000, v17
    v_fmac_f32 v40, v36, v30
    v_add_f32 v42, v42, v36
    v_sub_f32 v42, v42, v37
    v_fmac_f32 v40, v37, v31
    v_lshlrev_b32 v36, 16, v18
    v_and_b32 v37, 0xffff0000, v18
    v_fmac_f32 v40, v36, v32
    v_add_f32 v42, v42, v36
    v_sub_f32 v42, v42, v37
    v_fmac_f32 v40, v37, v33
    v_lshlrev_b32 v36, 16, v19
    v_and_b32 v37, 0xffff0000, v19
    v_fmac_f32 v40, v36, v34
    v_add_f32 v42, v42, v36
    v_sub_f32 v42, v42, v37
    v_fmac_f32 v40, v37, v35
    v_lshlrev_b32 v36, 16, v20
    v_and_b32 v37, 0xffff0000, v20
    v_mul_f32 v41, v36, v28
    v_sub_f32 v43, v36, v37
    v_fmac_f32 v41, v37, v29
    v_lshlrev_b32 v36, 16, v21
    v_and_b32 v37, 0xffff0000, v21
    v_fmac_f32 v41, v36, v30
    v_add_f32 v43, v43, v36
    v_sub_f32 v43, v43, v37
    v_fmac_f32 v41, v37, v31
    v_lshlrev_b32 v36, 16, v22
    v_and_b32 v37, 0xffff0000, v22
    v_fmac_f32 v41, v36, v32
    v_add_f32 v43, v43, v36
    v_sub_f32 v43, v43, v37
    v_fmac_f32 v41, v37, v33
    v_lshlrev_b32 v36, 16, v23
    v_and_b32 v37, 0xffff0000, v23
    v_fmac_f32 v41, v36, v34
    v_add_f32 v43, v43, v36
    v_sub_f32 v43, v43, v37
    v_fmac_f32 v41, v37, v35
    s_nop 1
    v_add_f32_dpp v40, v40, v40 quad_perm:[1,0,3,2] row_mask:0xf bank_mask:0xf
    v_add_f32_dpp v41, v41, v41 quad_perm:[1,0,3,2] row_mask:0xf bank_mask:0xf
    v_add_f32_dpp v42, v42, v42 quad_perm:[1,0,3,2] row_mask:0xf bank_mask:0xf
    v_add_f32_dpp v43, v43, v43 quad_perm:[1,0,3,2] row_mask:0xf bank_mask:0xf
    v_add_f32_dpp v40, v40, v40 quad_perm:[2,3,0,1] row_mask:0xf bank_mask:0xf
    v_add_f32_dpp v41, v41, v41 quad_perm:[2,3,0,1] row_mask:0xf bank_mask:0xf
    v_add_f32_dpp v42, v42, v42 quad_perm:[2,3,0,1] row_mask:0xf bank_mask:0xf
    v_add_f32_dpp v43, v43, v43 quad_perm:[2,3,0,1] row_mask:0xf bank_mask:0xf
    v_add_f32_dpp v40, v40, v40 row_half_mirror row_mask:0xf bank_mask:0xf
    v_add_f32_dpp v41, v41, v41 row_half_mirror row_mask:0xf bank_mask:0xf
    v_add_f32_dpp v42, v42, v42 row_half_mirror row_mask:0xf bank_mask:0xf
    v_add_f32_dpp v43, v43, v43 row_half_mirror row_mask:0xf bank_mask:0xf
    v_add_f32_dpp v40, v40, v40 row_mirror row_mask:0xf bank_mask:0xf
    v_add_f32_dpp v41, v41, v41 row_mirror row_mask:0xf bank_mask:0xf
    v_add_f32_dpp v42, v42, v42 row_mirror row_mask:0xf bank_mask:0xf
    v_add_f32_dpp v43, v43, v43 row_mirror row_mask:0xf bank_mask:0xf
    v_add_f32_dpp v40, v40, v40 row_bcast:15 row_mask:0xa bank_mask:0xf
    v_add_f32_dpp v41, v41, v41 row_bcast:15 row_mask:0xa bank_mask:0xf
    v_add_f32_dpp v42, v42, v42 row_bcast:15 row_mask:0xa bank_mask:0xf
    v_add_f32_dpp v43, v43, v43 row_bcast:15 row_mask:0xa bank_mask:0xf
    v_add_f32_dpp v40, v40, v40 row_bcast:31 row_mask:0xc bank_mask:0xf
    v_add_f32_dpp v41, v41, v41 row_bcast:31 row_mask:0xc bank_mask:0xf
    v_add_f32_dpp v42, v42, v42 row_bcast:31 row_mask:0xc bank_mask:0xf
    v_add_f32_dpp v43, v43, v43 row_bcast:31 row_mask:0xc bank_mask:0xf
    s_nop 1
    s_mov_b32 exec_lo, 0
    s_mov_b32 exec_hi, 0x80000000
    v_mul_f32 v40, 0xbfb8aa3b, v40
    v_exp_f32 v40, v40
    s_nop 0
    v_add_f32 v40, 1.0, v40
    v_rcp_f32 v40, v40
    v_mul_f32 v41, 0xbfb8aa3b, v41
    v_exp_f32 v41, v41
    s_nop 0
    v_add_f32 v41, 1.0, v41
    v_rcp_f32 v41, v41
    s_lshl_b32 s52, s50, 2
    s_lshl_b32 s53, s51, 2
    s_add_u32 s52, s52, 0x721000
    s_add_u32 s53, s53, 0x721000
    v_mov_b32 v8, 0
    buffer_store_dword v40, v8, s[16:19], s52 offen sc1
    buffer_store_dword v41, v8, s[16:19], s53 offen sc1
    s_cmp_eq_u32 s50, 0
    s_cbranch_scc0 K1_G2
    s_mov_b32 s52, 0x720400
    buffer_store_dword v43, v8, s[16:19], s52 offen sc1
    s_nop 1
    v_mov_b32 v43, 0
K1_G2:
    v_add_f32 v42, v42, v43
    s_lshr_b32 s52, s50, 4
    s_lshl_b32 s52, s52, 10
    s_bfe_u32 s53, s50, 0x10003
    s_lshl_b32 s53, s53, 9
    s_add_u32 s52, s52, s53
    s_and_b32 s53, s50, 7
    s_lshl_b32 s53, s53, 1
    s_add_u32 s52, s52, s53
    s_add_u32 s52, s52, 0x680000
    v_cvt_pk_bf16_f32 v42, v42, v42
    buffer_store_short v42, v8, s[16:19], s52 offen sc1
    s_mov_b64 exec, -1
    s_cmp_eq_u32 s36, 8
    s_cbranch_scc0 P1_END
    v_mov_b32 v5, 0
    s_mov_b32 s51, 0
K1_EPSPIN:
    buffer_load_dword v6, v5, s[92:95], 0 offen sc1
    s_waitcnt vmcnt(0)
    v_readfirstlane_b32 s65, v6
    s_add_u32 s51, s51, 1
    s_cmp_lg_u32 s65, 0
    s_cbranch_scc1 P1_END
    s_sleep 8
    s_cmp_lt_u32 s51, 0x40000
    s_cbranch_scc1 K1_EPSPIN
P1_END:
    s_load_dwordx4 s[24:27], s[0:1], 32
    s_load_dwordx2 s[28:29], s[0:1], 16
    s_load_dwordx2 s[84:85], s[0:1], 72
    s_waitcnt vmcnt(0)
    s_barrier
    s_lshl_b32 s66, s2, 7

    s_and_b32 s37, s2, 7
    s_lshr_b32 s38, s2, 3
    s_and_b32 s39, s38, 3
    s_lshl_b32 s40, s37, 2
    s_add_u32 s40, s40, s39
    s_lshr_b32 s41, s38, 2
    s_waitcnt lgkmcnt(0)
    s_mov_b32 s4, s34
    s_and_b32 s5, s35, 0xffff
    s_mov_b32 s6, 0x1000000
    s_mov_b32 s7, 0x20000
    s_mov_b32 s67, 0x200000
    s_cmp_eq_u32 s36, 8
    s_cbranch_scc0 K2_E2
    s_add_u32 s66, s66, 0x728000
    v_mov_b32 v2, s65
    v_mov_b32 v3, 0
    s_mov_b64 exec, 1
    buffer_store_dword v2, v3, s[4:7], s66 offen sc1
    s_mov_b64 exec, -1
K2_E2:
    s_cmp_ge_u32 s36, 8
    s_cbranch_scc1 K2_FNET
    s_and_b32 s42, s36, 3
    s_lshr_b32 s49, s36, 2
    s_lshl_b32 s43, s41, 3
    s_lshl_b32 s44, s42, 1
    s_add_u32 s44, s44, s43
    s_lshl_b32 s43, s40, 16
    s_lshl_b32 s44, s44, 10
    s_add_u32 s43, s43, s44
    v_lshlrev_b32 v1, 4, v0
    s_mov_b32 s45, s43
    s_lshl_b32 s50, s49, 15
    v_add_u32 v2, s50, v1
    v_lshrrev_b32 v3, 5, v0
    v_lshlrev_b32 v3, 8, v3
    v_and_b32 v28, 15, v0
    v_lshl_add_u32 v3, v28, 4, v3
    s_add_u32 s51, s50, 65536
    v_add_u32 v3, s51, v3
    v_add_u32 v28, 4, v0
    v_bfe_u32 v28, v28, 3, 1
    v_lshlrev_b32 v28, 6, v28
    v_and_b32 v29, 31, v0
    v_cmp_eq_u32 vcc, 16, v29
    v_max_u32 v29, 16, v28
    v_mov_b32 v30, 0
    v_cndmask_b32 v28, v29, v30, vcc
    v_add_u32 v28, 161280, v28
    v_bfe_u32 v29, v0, 4, 1
    v_cmp_eq_u32 vcc, 0, v29
    v_mov_b32 v30, 0
    v_mov_b32 v31, 2048
    v_mov_b32 v97, v3
    v_cndmask_b32 v3, v28, v3, vcc
    v_cndmask_b32 v96, v30, v31, vcc
    v_mov_b32 v64, 0
    v_mov_b32 v65, 0
    v_mov_b32 v66, 0
    v_mov_b32 v67, 0
    v_mov_b32 v68, 0
    v_mov_b32 v69, 0
    v_mov_b32 v70, 0
    v_mov_b32 v71, 0
    v_mov_b32 v72, 0
    v_mov_b32 v73, 0
    v_mov_b32 v74, 0
    v_mov_b32 v75, 0
    v_mov_b32 v76, 0
    v_mov_b32 v77, 0
    v_mov_b32 v78, 0
    v_mov_b32 v79, 0
    v_mov_b32 v80, 0
    v_mov_b32 v81, 0
    v_mov_b32 v82, 0
    v_mov_b32 v83, 0
    v_mov_b32 v84, 0
    v_mov_b32 v85, 0
    v_mov_b32 v86, 0
    v_mov_b32 v87, 0
    v_mov_b32 v88, 0
    v_mov_b32 v89, 0
    v_mov_b32 v90, 0
    v_mov_b32 v91, 0
    v_mov_b32 v92, 0
    v_mov_b32 v93, 0
    v_mov_b32 v94, 0
    v_mov_b32 v95, 0
    v_mov_b32 v28, 0
    v_mov_b32 v29, 0
    v_mov_b32 v30, 0
    v_mov_b32 v31, 0
    v_and_b32 v29, 31, v0
    v_cmp_eq_u32 vcc, 16, v29
    v_mov_b32 v30, 0x3f803f80
    v_mov_b32 v31, 0
    v_cndmask_b32 v98, v31, v30, vcc
    v_mov_b32 v16, v98
    v_mov_b32 v17, v98
    v_mov_b32 v18, v98
    v_mov_b32 v19, v98
    v_mov_b32 v20, 0
    v_mov_b32 v21, 0
    v_mov_b32 v22, 0
    v_mov_b32 v23, 0
    s_mov_b32 s46, 0x0000ffff
    s_mov_b32 s47, 0x0000ffff
    s_mov_b32 s48, 0
    s_setprio 3
    s_barrier
    buffer_load_dwordx4 v[4:7], v1, s[4:7], s45 offen sc1
    buffer_load_dwordx4 v[8:11], v1, s[4:7], s45 offen offset:1024 sc1
    s_barrier
    ds_read_b128 v[12:15], v2
    s_mov_b64 exec, s[46:47]
    ds_read_b128 v[16:19], v97
    s_mov_b64 exec, -1
    v_mov_b32 v99, 163516
    ds_read_b32 v100, v99
    s_waitcnt vmcnt(0) lgkmcnt(0)
    v_readfirstlane_b32 s66, v100
    v_mfma_f32_32x32x16_bf16 v[32:47], v[12:15], v[4:7], 0
    s_nop 15
    v_add_u32 v104, v96, v3
.p2align 6
K2_LOOP:
    v_mfma_f32_32x32x16_bf16 v[48:63], v[12:15], v[8:11], 0
    ds_read_b128 v[12:15], v2 offset:1024
    v_exp_f32 v32, v32
    v_exp_f32 v33, v33
    v_exp_f32 v34, v34
    v_exp_f32 v35, v35
    v_cvt_pk_bf16_f32 v24, v32, v33
    v_cvt_pk_bf16_f32 v25, v34, v35
    v_mfma_f32_32x32x16_bf16 v[80:95], v[20:23], v[28:31], v[80:95]
    ds_read_b128 v[20:23], v3 offset:512
    v_exp_f32 v36, v36
    v_exp_f32 v37, v37
    v_exp_f32 v38, v38
    v_exp_f32 v39, v39
    v_cvt_pk_bf16_f32 v26, v36, v37
    v_cvt_pk_bf16_f32 v27, v38, v39
    v_exp_f32 v40, v40
    v_exp_f32 v41, v41
    s_waitcnt lgkmcnt(2)
    v_mfma_f32_32x32x16_bf16 v[64:79], v[16:19], v[24:27], v[64:79]
    v_exp_f32 v42, v42
    v_exp_f32 v43, v43
    v_cvt_pk_bf16_f32 v28, v40, v41
    v_exp_f32 v44, v44
    v_exp_f32 v45, v45
    v_cvt_pk_bf16_f32 v29, v42, v43
    v_exp_f32 v46, v46
    v_exp_f32 v47, v47
    v_cvt_pk_bf16_f32 v30, v44, v45
    v_cvt_pk_bf16_f32 v31, v46, v47
    s_waitcnt lgkmcnt(0)
    v_mfma_f32_32x32x16_bf16 v[32:47], v[12:15], v[4:7], 0
    v_exp_f32 v48, v48
    v_exp_f32 v49, v49
    v_exp_f32 v50, v50
    v_exp_f32 v51, v51
    v_cvt_pk_bf16_f32 v24, v48, v49
    v_cvt_pk_bf16_f32 v25, v50, v51
    v_mfma_f32_32x32x16_bf16 v[64:79], v[20:23], v[28:31], v[64:79]
    v_exp_f32 v52, v52
    v_exp_f32 v53, v53
    v_exp_f32 v54, v54
    v_exp_f32 v55, v55
    v_cvt_pk_bf16_f32 v26, v52, v53
    v_cvt_pk_bf16_f32 v27, v54, v55
    v_exp_f32 v56, v56
    v_exp_f32 v57, v57
    v_mfma_f32_32x32x16_bf16 v[80:95], v[16:19], v[24:27], v[80:95]
    ds_read_b128 v[16:19], v3 offset:1024
    v_exp_f32 v58, v58
    v_exp_f32 v59, v59
    v_cvt_pk_bf16_f32 v28, v56, v57
    v_exp_f32 v60, v60
    v_exp_f32 v61, v61
    v_cvt_pk_bf16_f32 v29, v58, v59
    v_exp_f32 v62, v62
    v_exp_f32 v63, v63
    v_cvt_pk_bf16_f32 v30, v60, v61
    v_cvt_pk_bf16_f32 v31, v62, v63
    s_bitcmp1_b32 11, s48
    s_cbranch_scc0 K2_NOBAR
    s_add_u32 s52, s48, 1
    s_lshl_b32 s52, s52, 1
    s_and_b32 s52, s52, 12
    s_add_u32 s52, s52, 163504
    v_mov_b32 v99, s52
K2_CSPIN:
    ds_read_b32 v100, v99
    s_waitcnt lgkmcnt(0)
    v_readfirstlane_b32 s52, v100
    s_cmp_ge_u32 s52, 4
    s_cbranch_scc1 K2_NOBAR
    s_sub_u32 s67, s67, 1
    s_cmp_gt_i32 s67, 0
    s_cbranch_scc1 K2_CSPIN
K2_NOBAR:
    v_mfma_f32_32x32x16_bf16 v[48:63], v[12:15], v[8:11], 0
    ds_read_b128 v[12:15], v2 offset:2048
    v_exp_f32 v32, v32
    v_exp_f32 v33, v33
    v_exp_f32 v34, v34
    v_exp_f32 v35, v35
    v_cvt_pk_bf16_f32 v24, v32, v33
    v_cvt_pk_bf16_f32 v25, v34, v35
    v_mfma_f32_32x32x16_bf16 v[80:95], v[20:23], v[28:31], v[80:95]
    ds_read_b128 v[20:23], v3 offset:1536
    v_exp_f32 v36, v36
    v_exp_f32 v37, v37
    v_exp_f32 v38, v38
    v_exp_f32 v39, v39
    v_cvt_pk_bf16_f32 v26, v36, v37
    v_cvt_pk_bf16_f32 v27, v38, v39
    v_exp_f32 v40, v40
    v_exp_f32 v41, v41
    s_waitcnt lgkmcnt(2)
    v_mfma_f32_32x32x16_bf16 v[64:79], v[16:19], v[24:27], v[64:79]
    v_exp_f32 v42, v42
    v_exp_f32 v43, v43
    v_cvt_pk_bf16_f32 v28, v40, v41
    v_exp_f32 v44, v44
    v_exp_f32 v45, v45
    v_cvt_pk_bf16_f32 v29, v42, v43
    v_exp_f32 v46, v46
    v_exp_f32 v47, v47
    v_cvt_pk_bf16_f32 v30, v44, v45
    v_cvt_pk_bf16_f32 v31, v46, v47
    s_waitcnt lgkmcnt(0)
    v_mfma_f32_32x32x16_bf16 v[32:47], v[12:15], v[4:7], 0
    v_exp_f32 v48, v48
    v_exp_f32 v49, v49
    v_exp_f32 v50, v50
    v_exp_f32 v51, v51
    v_cvt_pk_bf16_f32 v24, v48, v49
    v_cvt_pk_bf16_f32 v25, v50, v51
    v_mfma_f32_32x32x16_bf16 v[64:79], v[20:23], v[28:31], v[64:79]
    v_exp_f32 v52, v52
    v_exp_f32 v53, v53
    v_exp_f32 v54, v54
    v_exp_f32 v55, v55
    v_cvt_pk_bf16_f32 v26, v52, v53
    v_cvt_pk_bf16_f32 v27, v54, v55
    v_exp_f32 v56, v56
    v_exp_f32 v57, v57
    v_mfma_f32_32x32x16_bf16 v[80:95], v[16:19], v[24:27], v[80:95]
    ds_read_b128 v[16:19], v3 offset:2048
    v_exp_f32 v58, v58
    v_exp_f32 v59, v59
    v_cvt_pk_bf16_f32 v28, v56, v57
    v_exp_f32 v60, v60
    v_exp_f32 v61, v61
    v_cvt_pk_bf16_f32 v29, v58, v59
    v_exp_f32 v62, v62
    v_exp_f32 v63, v63
    v_cvt_pk_bf16_f32 v30, v60, v61
    v_cvt_pk_bf16_f32 v31, v62, v63
    v_mfma_f32_32x32x16_bf16 v[48:63], v[12:15], v[8:11], 0
    ds_read_b128 v[12:15], v2 offset:3072
    v_exp_f32 v32, v32
    v_exp_f32 v33, v33
    v_exp_f32 v34, v34
    v_exp_f32 v35, v35
    v_cvt_pk_bf16_f32 v24, v32, v33
    v_cvt_pk_bf16_f32 v25, v34, v35
    v_mfma_f32_32x32x16_bf16 v[80:95], v[20:23], v[28:31], v[80:95]
    ds_read_b128 v[20:23], v104 offset:512
    v_exp_f32 v36, v36
    v_exp_f32 v37, v37
    v_exp_f32 v38, v38
    v_exp_f32 v39, v39
    v_cvt_pk_bf16_f32 v26, v36, v37
    v_cvt_pk_bf16_f32 v27, v38, v39
    v_exp_f32 v40, v40
    v_exp_f32 v41, v41
    s_waitcnt lgkmcnt(2)
    v_mfma_f32_32x32x16_bf16 v[64:79], v[16:19], v[24:27], v[64:79]
    v_exp_f32 v42, v42
    v_exp_f32 v43, v43
    v_cvt_pk_bf16_f32 v28, v40, v41
    v_exp_f32 v44, v44
    v_exp_f32 v45, v45
    v_cvt_pk_bf16_f32 v29, v42, v43
    v_exp_f32 v46, v46
    v_exp_f32 v47, v47
    v_cvt_pk_bf16_f32 v30, v44, v45
    v_cvt_pk_bf16_f32 v31, v46, v47
    s_waitcnt lgkmcnt(0)
    v_mfma_f32_32x32x16_bf16 v[32:47], v[12:15], v[4:7], 0
    v_exp_f32 v48, v48
    v_exp_f32 v49, v49
    v_exp_f32 v50, v50
    v_exp_f32 v51, v51
    v_cvt_pk_bf16_f32 v24, v48, v49
    v_cvt_pk_bf16_f32 v25, v50, v51
    v_mfma_f32_32x32x16_bf16 v[64:79], v[20:23], v[28:31], v[64:79]
    v_exp_f32 v52, v52
    v_exp_f32 v53, v53
    v_exp_f32 v54, v54
    v_exp_f32 v55, v55
    v_cvt_pk_bf16_f32 v26, v52, v53
    v_cvt_pk_bf16_f32 v27, v54, v55
    v_exp_f32 v56, v56
    v_exp_f32 v57, v57
    v_mfma_f32_32x32x16_bf16 v[80:95], v[16:19], v[24:27], v[80:95]
    ds_read_b128 v[16:19], v104 offset:1024
    v_exp_f32 v58, v58
    v_exp_f32 v59, v59
    v_cvt_pk_bf16_f32 v28, v56, v57
    v_exp_f32 v60, v60
    v_exp_f32 v61, v61
    v_cvt_pk_bf16_f32 v29, v58, v59
    v_exp_f32 v62, v62
    v_exp_f32 v63, v63
    v_cvt_pk_bf16_f32 v30, v60, v61
    v_cvt_pk_bf16_f32 v31, v62, v63
    v_mfma_f32_32x32x16_bf16 v[48:63], v[12:15], v[8:11], 0
    ds_read_b128 v[12:15], v2 offset:4096
    v_exp_f32 v32, v32
    v_exp_f32 v33, v33
    v_exp_f32 v34, v34
    v_exp_f32 v35, v35
    v_cvt_pk_bf16_f32 v24, v32, v33
    v_cvt_pk_bf16_f32 v25, v34, v35
    v_mfma_f32_32x32x16_bf16 v[80:95], v[20:23], v[28:31], v[80:95]
    ds_read_b128 v[20:23], v104 offset:1536
    v_exp_f32 v36, v36
    v_exp_f32 v37, v37
    v_exp_f32 v38, v38
    v_exp_f32 v39, v39
    v_cvt_pk_bf16_f32 v26, v36, v37
    v_cvt_pk_bf16_f32 v27, v38, v39
    v_exp_f32 v40, v40
    v_exp_f32 v41, v41
    s_waitcnt lgkmcnt(2)
    v_mfma_f32_32x32x16_bf16 v[64:79], v[16:19], v[24:27], v[64:79]
    v_exp_f32 v42, v42
    v_exp_f32 v43, v43
    v_cvt_pk_bf16_f32 v28, v40, v41
    v_exp_f32 v44, v44
    v_exp_f32 v45, v45
    v_cvt_pk_bf16_f32 v29, v42, v43
    v_exp_f32 v46, v46
    v_exp_f32 v47, v47
    v_cvt_pk_bf16_f32 v30, v44, v45
    v_cvt_pk_bf16_f32 v31, v46, v47
    s_waitcnt lgkmcnt(0)
    v_mfma_f32_32x32x16_bf16 v[32:47], v[12:15], v[4:7], 0
    v_exp_f32 v48, v48
    v_exp_f32 v49, v49
    v_exp_f32 v50, v50
    v_exp_f32 v51, v51
    v_cvt_pk_bf16_f32 v24, v48, v49
    v_cvt_pk_bf16_f32 v25, v50, v51
    v_mfma_f32_32x32x16_bf16 v[64:79], v[20:23], v[28:31], v[64:79]
    v_exp_f32 v52, v52
    v_exp_f32 v53, v53
    v_exp_f32 v54, v54
    v_exp_f32 v55, v55
    v_cvt_pk_bf16_f32 v26, v52, v53
    v_cvt_pk_bf16_f32 v27, v54, v55
    v_exp_f32 v56, v56
    v_exp_f32 v57, v57
    v_mfma_f32_32x32x16_bf16 v[80:95], v[16:19], v[24:27], v[80:95]
    ds_read_b128 v[16:19], v104 offset:2048
    v_exp_f32 v58, v58
    v_exp_f32 v59, v59
    v_cvt_pk_bf16_f32 v28, v56, v57
    v_exp_f32 v60, v60
    v_exp_f32 v61, v61
    v_cvt_pk_bf16_f32 v29, v58, v59
    v_exp_f32 v62, v62
    v_exp_f32 v63, v63
    v_cvt_pk_bf16_f32 v30, v60, v61
    v_cvt_pk_bf16_f32 v31, v62, v63
    v_add_u32 v2, 0x1000, v2
    v_add_u32 v3, v96, v104
    v_add_u32 v104, v96, v3
    s_add_u32 s48, s48, 1
    s_and_b32 s52, s48, 1
    s_cbranch_scc1 K2_PRD
    s_cmp_eq_u32 s48, 2
    s_cbranch_scc0 K2_PR_1
    s_setprio 2
K2_PR_1:
    s_cmp_eq_u32 s48, 4
    s_cbranch_scc0 K2_PR_2
    s_setprio 1
K2_PR_2:
    s_cmp_eq_u32 s48, 6
    s_cbranch_scc0 K2_PR_3
    s_setprio 0
K2_PR_3:
K2_PRD:
    s_cmp_lt_u32 s48, 8
    s_cbranch_scc1 K2_LOOP
    v_mfma_f32_32x32x16_bf16 v[80:95], v[20:23], v[28:31], v[80:95]
    s_waitcnt lgkmcnt(0)
    s_nop 15
    s_cmp_eq_u32 s49, 0
    s_cbranch_scc1 K2_KEEPA
    v_mov_b32 v32, v64
    v_mov_b32 v64, v80
    v_mov_b32 v33, v65
    v_mov_b32 v65, v81
    v_mov_b32 v34, v66
    v_mov_b32 v66, v82
    v_mov_b32 v35, v67
    v_mov_b32 v67, v83
    v_mov_b32 v36, v68
    v_mov_b32 v68, v84
    v_mov_b32 v37, v69
    v_mov_b32 v69, v85
    v_mov_b32 v38, v70
    v_mov_b32 v70, v86
    v_mov_b32 v39, v71
    v_mov_b32 v71, v87
    v_mov_b32 v40, v72
    v_mov_b32 v72, v88
    s_add_u32 s43, s43, 1024
    s_branch K2_XCH
K2_KEEPA:
    v_mov_b32 v32, v80
    v_mov_b32 v33, v81
    v_mov_b32 v34, v82
    v_mov_b32 v35, v83
    v_mov_b32 v36, v84
    v_mov_b32 v37, v85
    v_mov_b32 v38, v86
    v_mov_b32 v39, v87
    v_mov_b32 v40, v88
K2_XCH:
    s_mul_i32 s50, s36, 2304
    s_add_u32 s50, s50, 143360
    v_lshlrev_b32 v28, 2, v0
    v_add_u32 v29, s50, v28
    ds_write_b32 v29, v32 offset:0
    ds_write_b32 v29, v33 offset:256
    ds_write_b32 v29, v34 offset:512
    ds_write_b32 v29, v35 offset:768
    ds_write_b32 v29, v36 offset:1024
    ds_write_b32 v29, v37 offset:1280
    ds_write_b32 v29, v38 offset:1536
    ds_write_b32 v29, v39 offset:1792
    ds_write_b32 v29, v40 offset:2048
    s_lshl_b32 s51, s36, 2
    s_add_u32 s51, s51, 163472
    v_mov_b32 v30, s51
    v_mov_b32 v31, 1
    s_waitcnt lgkmcnt(0)
    ds_write_b32 v30, v31
    s_xor_b32 s52, s36, 4
    s_mul_i32 s50, s52, 2304
    s_add_u32 s50, s50, 143360
    v_add_u32 v29, s50, v28
    s_lshl_b32 s51, s52, 2
    s_add_u32 s51, s51, 163472
    v_mov_b32 v30, s51
K2_XSPIN:
    ds_read_b32 v31, v30
    s_waitcnt lgkmcnt(0)
    v_readfirstlane_b32 s52, v31
    s_cmp_eq_u32 s52, 1
    s_cbranch_scc1 K2_XGO
    s_sleep 1
    s_sub_u32 s67, s67, 1
    s_cmp_gt_i32 s67, 0
    s_cbranch_scc1 K2_XSPIN
K2_XGO:
    ds_read_b32 v32, v29 offset:0
    ds_read_b32 v33, v29 offset:256
    ds_read_b32 v34, v29 offset:512
    ds_read_b32 v35, v29 offset:768
    ds_read_b32 v36, v29 offset:1024
    ds_read_b32 v37, v29 offset:1280
    ds_read_b32 v38, v29 offset:1536
    ds_read_b32 v39, v29 offset:1792
    ds_read_b32 v40, v29 offset:2048
    s_waitcnt lgkmcnt(0)
    v_add_f32 v64, v64, v32
    v_add_f32 v65, v65, v33
    v_add_f32 v66, v66, v34
    v_add_f32 v67, v67, v35
    v_add_f32 v68, v68, v36
    v_add_f32 v69, v69, v37
    v_add_f32 v70, v70, v38
    v_add_f32 v71, v71, v39
    v_add_f32 v72, v72, v40
    v_mov_b32 v29, v72
    s_nop 1
    v_permlane32_swap_b32 v29, v72
    s_nop 1
    v_mov_b32 v72, v29
    v_rcp_f32 v28, v72
    s_nop 0
    v_mul_f32 v64, v64, v28
    v_mul_f32 v65, v65, v28
    v_mul_f32 v66, v66, v28
    v_mul_f32 v67, v67, v28
    v_mul_f32 v68, v68, v28
    v_mul_f32 v69, v69, v28
    v_mul_f32 v70, v70, v28
    v_mul_f32 v71, v71, v28
    v_mov_b32 v29, v72
    v_add_f32 v30, abs(v64), abs(v65)
    v_add_f32 v30, v30, abs(v66)
    v_add_f32 v30, v30, abs(v67)
    v_add_f32 v30, v30, abs(v68)
    v_add_f32 v30, v30, abs(v69)
    v_add_f32 v30, v30, abs(v70)
    v_add_f32 v30, v30, abs(v71)
    v_cmp_nle_f32 vcc, 0x21800000, v29
    s_mov_b32 s50, 0x5d800000
    v_cmp_nle_f32 s[52:53], v29, s50
    s_mov_b32 s50, 0x7e800000
    v_cmp_nle_f32 s[54:55], v30, s50
    s_nop 4
    s_or_b64 vcc, vcc, s[52:53]
    s_or_b64 vcc, vcc, s[54:55]
    s_cmp_lg_u64 vcc, 0
    s_cbranch_scc1 K2_FALLBACK
K2_STORE:
    v_cvt_pk_bf16_f32 v24, v64, v65
    v_cvt_pk_bf16_f32 v25, v66, v67
    v_cvt_pk_bf16_f32 v26, v68, v69
    v_cvt_pk_bf16_f32 v27, v70, v71
    s_add_u32 s45, s43, 0x800000
    buffer_store_dwordx4 v[24:27], v1, s[4:7], s45 offen sc1
    s_lshl_b32 s50, s40, 5
    s_lshl_b32 s51, s41, 2
    s_add_u32 s50, s50, s51
    s_and_b32 s51, s36, 3
    s_add_u32 s50, s50, s51
    s_lshl_b32 s50, s50, 7
    s_lshl_b32 s51, s49, 2
    s_add_u32 s50, s50, s51
    s_add_u32 s50, s50, 0x740000
    v_mov_b32 v28, s66
    v_mov_b32 v29, 0
    s_waitcnt vmcnt(0)
    s_mov_b64 exec, 1
    buffer_store_dword v28, v29, s[4:7], s50 offen sc1
    s_mov_b64 exec, -1
    s_branch K2_PHASE3B
K2_FALLBACK:
    s_cmp_eq_u32 s49, 0
    s_cbranch_scc1 K2_FB0
    v_mov_b32 v4, v8
    v_mov_b32 v5, v9
    v_mov_b32 v6, v10
    v_mov_b32 v7, v11
K2_FB0:
    v_mov_b32 v2, v1
    v_mov_b32 v29, 0xff800000
    s_mov_b32 s48, 0
K2_FB1:
    ds_read_b128 v[12:15], v2
    s_waitcnt lgkmcnt(0)
    v_mfma_f32_32x32x16_bf16 v[32:47], v[12:15], v[4:7], 0
    s_nop 15
    v_max3_f32 v29, v32, v33, v29
    v_max3_f32 v29, v34, v35, v29
    v_max3_f32 v29, v36, v37, v29
    v_max3_f32 v29, v38, v39, v29
    v_max3_f32 v29, v40, v41, v29
    v_max3_f32 v29, v42, v43, v29
    v_max3_f32 v29, v44, v45, v29
    v_max3_f32 v29, v46, v47, v29
    v_add_u32 v2, 1024, v2
    s_add_u32 s48, s48, 1
    s_cmp_lt_u32 s48, 64
    s_cbranch_scc1 K2_FB1
    v_mov_b32 v30, v29
    s_nop 1
    v_permlane32_swap_b32 v30, v29
    s_nop 1
    v_max_f32 v29, v29, v30
    v_sub_f32 v100, 0, v29
    v_sub_f32 v101, 0, v29
    v_sub_f32 v102, 0, v29
    v_sub_f32 v103, 0, v29
    v_sub_f32 v104, 0, v29
    v_sub_f32 v105, 0, v29
    v_sub_f32 v106, 0, v29
    v_sub_f32 v107, 0, v29
    v_sub_f32 v108, 0, v29
    v_sub_f32 v109, 0, v29
    v_sub_f32 v110, 0, v29
    v_sub_f32 v111, 0, v29
    v_sub_f32 v112, 0, v29
    v_sub_f32 v113, 0, v29
    v_sub_f32 v114, 0, v29
    v_sub_f32 v115, 0, v29
    v_mov_b32 v64, 0
    v_mov_b32 v65, 0
    v_mov_b32 v66, 0
    v_mov_b32 v67, 0
    v_mov_b32 v68, 0
    v_mov_b32 v69, 0
    v_mov_b32 v70, 0
    v_mov_b32 v71, 0
    v_mov_b32 v72, 0
    v_mov_b32 v73, 0
    v_mov_b32 v74, 0
    v_mov_b32 v75, 0
    v_mov_b32 v76, 0
    v_mov_b32 v77, 0
    v_mov_b32 v78, 0
    v_mov_b32 v79, 0
    v_mov_b32 v16, v98
    v_mov_b32 v17, v98
    v_mov_b32 v18, v98
    v_mov_b32 v19, v98
    v_mov_b32 v20, v98
    v_mov_b32 v21, v98
    v_mov_b32 v22, v98
    v_mov_b32 v23, v98
    v_mov_b32 v2, v1
    s_lshl_b32 s50, s49, 15
    v_subrev_u32 v3, s50, v97
    s_mov_b32 s48, 0
K2_FB2:
    ds_read_b128 v[12:15], v2
    s_mov_b64 exec, s[46:47]
    ds_read_b128 v[16:19], v3
    ds_read_b128 v[20:23], v3 offset:512
    s_mov_b64 exec, -1
    s_waitcnt lgkmcnt(0)
    v_mfma_f32_32x32x16_bf16 v[32:47], v[12:15], v[4:7], v[100:115]
    s_nop 15
    v_exp_f32 v32, v32
    v_exp_f32 v33, v33
    v_exp_f32 v34, v34
    v_exp_f32 v35, v35
    v_exp_f32 v36, v36
    v_exp_f32 v37, v37
    v_exp_f32 v38, v38
    v_exp_f32 v39, v39
    v_exp_f32 v40, v40
    v_exp_f32 v41, v41
    v_exp_f32 v42, v42
    v_exp_f32 v43, v43
    v_exp_f32 v44, v44
    v_exp_f32 v45, v45
    v_exp_f32 v46, v46
    v_exp_f32 v47, v47
    s_nop 0
    v_cvt_pk_bf16_f32 v24, v32, v33
    v_cvt_pk_bf16_f32 v25, v34, v35
    v_cvt_pk_bf16_f32 v26, v36, v37
    v_cvt_pk_bf16_f32 v27, v38, v39
    v_cvt_pk_bf16_f32 v28, v40, v41
    v_cvt_pk_bf16_f32 v29, v42, v43
    v_cvt_pk_bf16_f32 v30, v44, v45
    v_cvt_pk_bf16_f32 v31, v46, v47
    s_nop 1
    v_mfma_f32_32x32x16_bf16 v[64:79], v[16:19], v[24:27], v[64:79]
    v_mfma_f32_32x32x16_bf16 v[64:79], v[20:23], v[28:31], v[64:79]
    v_add_u32 v2, 1024, v2
    v_add_u32 v3, 1024, v3
    s_add_u32 s48, s48, 1
    s_cmp_lt_u32 s48, 64
    s_cbranch_scc1 K2_FB2
    s_nop 15
    v_mov_b32 v29, v72
    s_nop 1
    v_permlane32_swap_b32 v29, v72
    s_nop 1
    v_mov_b32 v72, v29
    v_rcp_f32 v28, v72
    s_nop 0
    v_mul_f32 v64, v64, v28
    v_mul_f32 v65, v65, v28
    v_mul_f32 v66, v66, v28
    v_mul_f32 v67, v67, v28
    v_mul_f32 v68, v68, v28
    v_mul_f32 v69, v69, v28
    v_mul_f32 v70, v70, v28
    v_mul_f32 v71, v71, v28
    s_branch K2_STORE
K2_FNET:
    s_setprio 3
    s_sub_u32 s42, s36, 8
    v_lshlrev_b32 v1, 4, v0
    s_lshl_b32 s43, s40, 16
    s_add_u32 s44, s43, 0x200000
    s_add_u32 s45, s43, 0x400000
    s_lshr_b32 s52, s42, 1
    s_lshl_b32 s52, s52, 15
    s_and_b32 s53, s42, 1
    s_lshl_b32 s46, s53, 10
    s_add_u32 s46, s46, s52
    s_lshl_b32 s54, s53, 11
    s_add_u32 s54, s54, s52
    s_add_u32 s54, s54, 2048
    s_lshl_b32 s55, s53, 12
    s_add_u32 s55, s55, s52
    s_add_u32 s55, s55, 6144
    s_mul_i32 s56, s53, 9216
    s_add_u32 s56, s56, s52
    s_add_u32 s56, s56, 14336
    v_add_u32 v32, s46, v1
    v_add_u32 v33, 65536, v32
    v_add_u32 v34, s54, v1
    v_add_u32 v35, 65536, v34
    v_add_u32 v36, s55, v1
    v_add_u32 v37, 65536, v36
    v_add_u32 v38, s56, v1
    v_add_u32 v39, 65536, v38
    v_and_b32 v5, 15, v0
    v_cmp_eq_u32 vcc, 0, v5
    v_mov_b32 v6, 0x3f803f80
    v_mov_b32 v7, 0
    v_cndmask_b32 v4, v7, v6, vcc
    v_mov_b32 v5, v4
    v_mov_b32 v6, v4
    v_mov_b32 v7, v4
    v_add_u32 v2, 161792, v1
    ds_write_b128 v2, v[4:7]
    s_mov_b32 exec_lo, -1
    s_mov_b32 exec_hi, 0xff
    ds_write_b128 v2, v[4:7] offset:1024
    s_mov_b64 exec, -1
    s_cmp_eq_u32 s36, 8
    s_cbranch_scc0 K2_NOEPL
    s_mov_b64 exec, 0x1f
    v_mov_b32 v4, 0
    v_mov_b32 v5, 0
    v_mov_b32 v6, 0
    v_mov_b32 v7, 0
    v_add_u32 v2, 163456, v1
    ds_write_b128 v2, v[4:7]
    s_mov_b64 exec, -1
    s_waitcnt lgkmcnt(0)
    v_mov_b32 v2, 163516
    v_mov_b32 v4, s65
    ds_write_b32 v2, v4
K2_NOEPL:
    s_waitcnt lgkmcnt(0)
    s_cmp_eq_u32 s36, 8
    s_cbranch_scc0 K2_E2L
    v_and_b32 v40, 1, v0
    v_bfe_u32 v41, v0, 1, 1
    v_bfe_u32 v42, v0, 2, 3
    v_lshl_add_u32 v41, v42, 2, v41
    s_and_b32 s52, s37, 1
    s_lshl_b32 s52, s52, 1
    v_add_u32 v41, s52, v41
    v_lshl_add_u32 v40, v41, 3, v40
    s_and_b32 s52, s37, 6
    v_add_u32 v40, s52, v40
    v_lshlrev_b32 v40, 7, v40
    s_mov_b32 s52, 0x728000
    s_mov_b32 s51, 0
    s_sleep 8
K2_POLL1:
    buffer_load_dword v41, v40, s[4:7], s52 offen sc1
    s_waitcnt vmcnt(0)
    v_cmp_ne_u32 vcc, s65, v41
    s_add_u32 s51, s51, 1
    s_nop 3
    s_cmp_eq_u64 vcc, 0
    s_cbranch_scc1 K2_E2P
    s_sleep 4
    s_cmp_lt_u32 s51, 0x40000
    s_cbranch_scc1 K2_POLL1
K2_E2P:
K2_E2L:
    s_barrier
    s_add_u32 s47, s44, s46
    buffer_load_dwordx4 v[8:11], v1, s[4:7], s47 offen sc1
    s_add_u32 s47, s45, s46
    buffer_load_dwordx4 v[12:15], v1, s[4:7], s47 offen sc1
    s_add_u32 s47, s44, s54
    buffer_load_dwordx4 v[16:19], v1, s[4:7], s47 offen sc1
    s_add_u32 s47, s45, s54
    buffer_load_dwordx4 v[20:23], v1, s[4:7], s47 offen sc1
    s_add_u32 s47, s44, s54
    s_add_u32 s47, s47, 1024
    buffer_load_dwordx4 v[24:27], v1, s[4:7], s47 offen sc1
    s_add_u32 s47, s45, s54
    s_add_u32 s47, s47, 1024
    buffer_load_dwordx4 v[28:31], v1, s[4:7], s47 offen sc1
    s_waitcnt vmcnt(4)
    ds_write_b128 v32, v[8:11] offset:0
    ds_write_b128 v33, v[12:15] offset:0
    s_waitcnt lgkmcnt(0)
    s_barrier
    s_waitcnt vmcnt(0)
    ds_write_b128 v34, v[16:19] offset:0
    ds_write_b128 v35, v[20:23] offset:0
    ds_write_b128 v34, v[24:27] offset:1024
    ds_write_b128 v35, v[28:31] offset:1024
    v_mov_b32 v4, 163504
    v_mov_b32 v5, 1
    s_waitcnt lgkmcnt(0)
    s_mov_b64 exec, 1
    ds_add_u32 v4, v5
    s_mov_b64 exec, -1
    s_add_u32 s47, s44, s55
    buffer_load_dwordx4 v[40:43], v1, s[4:7], s47 offen sc1
    s_add_u32 s47, s45, s55
    buffer_load_dwordx4 v[44:47], v1, s[4:7], s47 offen sc1
    s_add_u32 s47, s44, s55
    s_add_u32 s47, s47, 1024
    buffer_load_dwordx4 v[48:51], v1, s[4:7], s47 offen sc1
    s_add_u32 s47, s45, s55
    s_add_u32 s47, s47, 1024
    buffer_load_dwordx4 v[52:55], v1, s[4:7], s47 offen sc1
    s_add_u32 s47, s44, s55
    s_add_u32 s47, s47, 2048
    buffer_load_dwordx4 v[56:59], v1, s[4:7], s47 offen sc1
    s_add_u32 s47, s45, s55
    s_add_u32 s47, s47, 2048
    buffer_load_dwordx4 v[60:63], v1, s[4:7], s47 offen sc1
    s_add_u32 s47, s44, s55
    s_add_u32 s47, s47, 3072
    buffer_load_dwordx4 v[64:67], v1, s[4:7], s47 offen sc1
    s_add_u32 s47, s45, s55
    s_add_u32 s47, s47, 3072
    buffer_load_dwordx4 v[68:71], v1, s[4:7], s47 offen sc1
    s_add_u32 s47, s44, s56
    buffer_load_dwordx4 v[72:75], v1, s[4:7], s47 offen sc1
    s_add_u32 s47, s45, s56
    buffer_load_dwordx4 v[76:79], v1, s[4:7], s47 offen sc1
    s_add_u32 s47, s44, s56
    s_add_u32 s47, s47, 1024
    buffer_load_dwordx4 v[80:83], v1, s[4:7], s47 offen sc1
    s_add_u32 s47, s45, s56
    s_add_u32 s47, s47, 1024
    buffer_load_dwordx4 v[84:87], v1, s[4:7], s47 offen sc1
    s_add_u32 s47, s44, s56
    s_add_u32 s47, s47, 2048
    buffer_load_dwordx4 v[88:91], v1, s[4:7], s47 offen sc1
    s_add_u32 s47, s45, s56
    s_add_u32 s47, s47, 2048
    buffer_load_dwordx4 v[92:95], v1, s[4:7], s47 offen sc1
    s_add_u32 s47, s44, s56
    s_add_u32 s47, s47, 3072
    buffer_load_dwordx4 v[96:99], v1, s[4:7], s47 offen sc1
    s_add_u32 s47, s45, s56
    s_add_u32 s47, s47, 3072
    buffer_load_dwordx4 v[100:103], v1, s[4:7], s47 offen sc1
    s_waitcnt vmcnt(14)
    ds_write_b128 v36, v[40:43] offset:0
    ds_write_b128 v37, v[44:47] offset:0
    s_waitcnt vmcnt(12)
    ds_write_b128 v36, v[48:51] offset:1024
    ds_write_b128 v37, v[52:55] offset:1024
    s_waitcnt vmcnt(10)
    ds_write_b128 v36, v[56:59] offset:2048
    ds_write_b128 v37, v[60:63] offset:2048
    s_waitcnt vmcnt(8)
    ds_write_b128 v36, v[64:67] offset:3072
    ds_write_b128 v37, v[68:71] offset:3072
    s_waitcnt lgkmcnt(0)
    s_mov_b64 exec, 1
    ds_add_u32 v4, v5 offset:4
    s_mov_b64 exec, -1
    s_add_u32 s47, s44, s56
    s_add_u32 s47, s47, 4096
    buffer_load_dwordx4 v[104:107], v1, s[4:7], s47 offen sc1
    s_add_u32 s47, s45, s56
    s_add_u32 s47, s47, 4096
    buffer_load_dwordx4 v[108:111], v1, s[4:7], s47 offen sc1
    s_add_u32 s47, s44, s56
    s_add_u32 s47, s47, 5120
    buffer_load_dwordx4 v[112:115], v1, s[4:7], s47 offen sc1
    s_add_u32 s47, s45, s56
    s_add_u32 s47, s47, 5120
    buffer_load_dwordx4 v[116:119], v1, s[4:7], s47 offen sc1
    s_add_u32 s47, s44, s56
    s_add_u32 s47, s47, 6144
    buffer_load_dwordx4 v[120:123], v1, s[4:7], s47 offen sc1
    s_add_u32 s47, s45, s56
    s_add_u32 s47, s47, 6144
    buffer_load_dwordx4 v[124:127], v1, s[4:7], s47 offen sc1
    s_add_u32 s47, s44, s56
    s_add_u32 s47, s47, 7168
    buffer_load_dwordx4 v[128:131], v1, s[4:7], s47 offen sc1
    s_add_u32 s47, s45, s56
    s_add_u32 s47, s47, 7168
    buffer_load_dwordx4 v[132:135], v1, s[4:7], s47 offen sc1
    s_add_u32 s47, s44, s56
    s_add_u32 s47, s47, 8192
    buffer_load_dwordx4 v[136:139], v1, s[4:7], s47 offen sc1
    s_add_u32 s47, s45, s56
    s_add_u32 s47, s47, 8192
    buffer_load_dwordx4 v[140:143], v1, s[4:7], s47 offen sc1
    s_waitcnt vmcnt(16)
    ds_write_b128 v38, v[72:75] offset:0
    ds_write_b128 v39, v[76:79] offset:0
    s_waitcnt vmcnt(14)
    ds_write_b128 v38, v[80:83] offset:1024
    ds_write_b128 v39, v[84:87] offset:1024
    s_waitcnt vmcnt(12)
    ds_write_b128 v38, v[88:91] offset:2048
    ds_write_b128 v39, v[92:95] offset:2048
    s_waitcnt vmcnt(10)
    ds_write_b128 v38, v[96:99] offset:3072
    ds_write_b128 v39, v[100:103] offset:3072
    s_waitcnt vmcnt(8)
    ds_write_b128 v38, v[104:107] offset:4096
    ds_write_b128 v39, v[108:111] offset:4096
    s_waitcnt vmcnt(6)
    ds_write_b128 v38, v[112:115] offset:5120
    ds_write_b128 v39, v[116:119] offset:5120
    s_waitcnt vmcnt(4)
    ds_write_b128 v38, v[120:123] offset:6144
    ds_write_b128 v39, v[124:127] offset:6144
    s_waitcnt vmcnt(2)
    ds_write_b128 v38, v[128:131] offset:7168
    ds_write_b128 v39, v[132:135] offset:7168
    s_waitcnt vmcnt(0)
    ds_write_b128 v38, v[136:139] offset:8192
    ds_write_b128 v39, v[140:143] offset:8192
    s_waitcnt lgkmcnt(0)
    s_mov_b64 exec, 1
    ds_add_u32 v4, v5 offset:8
    s_mov_b64 exec, -1
    s_lshl_b32 s56, s40, 5
    v_and_b32 v2, 31, v0
    v_add_u32 v3, s56, v2
    v_lshlrev_b32 v2, 12, v3
    v_lshrrev_b32 v4, 5, v0
    v_lshl_add_u32 v2, v4, 4, v2
    s_and_b32 s57, s42, 1
    s_lshl_b32 s57, s57, 5
    s_mov_b32 s58, 0x6a0000
    s_cmp_lt_u32 s42, 2
    s_cselect_b32 s8, s24, s26
    s_cselect_b32 s9, s25, s27
    s_cselect_b32 s58, 0x600000, s58
    s_and_b32 s9, s9, 0xffff
    s_mov_b32 s10, 0x800000
    s_mov_b32 s11, 0x20000
    s_lshl_b32 s56, s41, 16
    s_add_u32 s60, s56, s58
    s_lshl_b32 s56, s57, 10
    s_add_u32 s60, s60, s56
    s_lshl_b32 s62, s57, 5
    v_mov_b32 v4, 163468
    s_cmp_eq_u32 s36, 8
    s_cbranch_scc0 K2_FWAIT
    v_lshlrev_b32 v5, 7, v0
    s_mov_b32 s52, 0x728000
    s_mov_b32 s51, 0
K2_POLLF:
    s_add_u32 s53, s52, 0
    buffer_load_dword v8, v5, s[4:7], s53 offen sc1
    s_add_u32 s53, s52, 8192
    buffer_load_dword v9, v5, s[4:7], s53 offen sc1
    s_add_u32 s53, s52, 16384
    buffer_load_dword v10, v5, s[4:7], s53 offen sc1
    s_add_u32 s53, s52, 24576
    buffer_load_dword v11, v5, s[4:7], s53 offen sc1
    s_waitcnt vmcnt(0)
    v_xor_b32 v8, s65, v8
    v_xor_b32 v9, s65, v9
    v_xor_b32 v10, s65, v10
    v_xor_b32 v11, s65, v11
    v_or_b32 v8, v8, v9
    v_or3_b32 v8, v8, v10, v11
    v_cmp_ne_u32 vcc, 0, v8
    s_add_u32 s51, s51, 1
    s_nop 3
    s_cmp_eq_u64 vcc, 0
    s_cbranch_scc1 K2_FGO
    s_sleep 8
    s_cmp_lt_u32 s51, 0x40000
    s_cbranch_scc1 K2_POLLF
K2_FGO:
    v_mov_b32 v5, 1
    ds_write_b32 v4, v5
    s_waitcnt lgkmcnt(0)
    s_branch K2_FSTART
K2_FWAIT:
    ds_read_b32 v5, v4
    s_waitcnt lgkmcnt(0)
    v_readfirstlane_b32 s52, v5
    s_cmp_eq_u32 s52, 1
    s_cbranch_scc1 K2_FSTART
    s_sleep 4
    s_sub_u32 s67, s67, 1
    s_cmp_gt_i32 s67, 0
    s_cbranch_scc1 K2_FWAIT
K2_FSTART:
    s_setprio 2
    s_add_u32 s58, s60, 0
    s_add_u32 s59, s62, 0
    buffer_load_dwordx4 v[8:11], v1, s[4:7], s58 offen sc1
    buffer_load_dwordx4 v[12:15], v2, s[8:11], s59 offen
    s_add_u32 s58, s60, 1024
    s_add_u32 s59, s62, 32
    buffer_load_dwordx4 v[16:19], v1, s[4:7], s58 offen sc1
    buffer_load_dwordx4 v[20:23], v2, s[8:11], s59 offen
    s_add_u32 s58, s60, 2048
    s_add_u32 s59, s62, 64
    buffer_load_dwordx4 v[24:27], v1, s[4:7], s58 offen sc1
    buffer_load_dwordx4 v[28:31], v2, s[8:11], s59 offen
    s_add_u32 s58, s60, 3072
    s_add_u32 s59, s62, 96
    buffer_load_dwordx4 v[32:35], v1, s[4:7], s58 offen sc1
    buffer_load_dwordx4 v[36:39], v2, s[8:11], s59 offen
    s_add_u32 s58, s60, 4096
    s_add_u32 s59, s62, 128
    buffer_load_dwordx4 v[40:43], v1, s[4:7], s58 offen sc1
    buffer_load_dwordx4 v[44:47], v2, s[8:11], s59 offen
    s_add_u32 s58, s60, 5120
    s_add_u32 s59, s62, 160
    buffer_load_dwordx4 v[48:51], v1, s[4:7], s58 offen sc1
    buffer_load_dwordx4 v[52:55], v2, s[8:11], s59 offen
    s_add_u32 s58, s60, 6144
    s_add_u32 s59, s62, 192
    buffer_load_dwordx4 v[56:59], v1, s[4:7], s58 offen sc1
    buffer_load_dwordx4 v[60:63], v2, s[8:11], s59 offen
    s_add_u32 s58, s60, 7168
    s_add_u32 s59, s62, 224
    buffer_load_dwordx4 v[64:67], v1, s[4:7], s58 offen sc1
    buffer_load_dwordx4 v[68:71], v2, s[8:11], s59 offen
    s_add_u32 s58, s60, 8192
    s_add_u32 s59, s62, 256
    buffer_load_dwordx4 v[72:75], v1, s[4:7], s58 offen sc1
    buffer_load_dwordx4 v[76:79], v2, s[8:11], s59 offen
    s_add_u32 s58, s60, 9216
    s_add_u32 s59, s62, 288
    buffer_load_dwordx4 v[80:83], v1, s[4:7], s58 offen sc1
    buffer_load_dwordx4 v[84:87], v2, s[8:11], s59 offen
    s_add_u32 s58, s60, 10240
    s_add_u32 s59, s62, 320
    buffer_load_dwordx4 v[88:91], v1, s[4:7], s58 offen sc1
    buffer_load_dwordx4 v[92:95], v2, s[8:11], s59 offen
    s_add_u32 s58, s60, 11264
    s_add_u32 s59, s62, 352
    buffer_load_dwordx4 v[96:99], v1, s[4:7], s58 offen sc1
    buffer_load_dwordx4 v[100:103], v2, s[8:11], s59 offen
    s_add_u32 s58, s60, 12288
    s_add_u32 s59, s62, 384
    buffer_load_dwordx4 v[104:107], v1, s[4:7], s58 offen sc1
    buffer_load_dwordx4 v[108:111], v2, s[8:11], s59 offen
    s_add_u32 s58, s60, 13312
    s_add_u32 s59, s62, 416
    buffer_load_dwordx4 v[112:115], v1, s[4:7], s58 offen sc1
    buffer_load_dwordx4 v[116:119], v2, s[8:11], s59 offen
    s_add_u32 s58, s60, 14336
    s_add_u32 s59, s62, 448
    buffer_load_dwordx4 v[120:123], v1, s[4:7], s58 offen sc1
    buffer_load_dwordx4 v[124:127], v2, s[8:11], s59 offen
    s_add_u32 s58, s60, 15360
    s_add_u32 s59, s62, 480
    buffer_load_dwordx4 v[128:131], v1, s[4:7], s58 offen sc1
    buffer_load_dwordx4 v[132:135], v2, s[8:11], s59 offen
    v_mov_b32 v136, 0
    v_mov_b32 v137, 0
    v_mov_b32 v138, 0
    v_mov_b32 v139, 0
    v_mov_b32 v140, 0
    v_mov_b32 v141, 0
    v_mov_b32 v142, 0
    v_mov_b32 v143, 0
    v_mov_b32 v144, 0
    v_mov_b32 v145, 0
    v_mov_b32 v146, 0
    v_mov_b32 v147, 0
    v_mov_b32 v148, 0
    v_mov_b32 v149, 0
    v_mov_b32 v150, 0
    v_mov_b32 v151, 0
    s_waitcnt vmcnt(30)
    v_mfma_f32_32x32x16_bf16 v[136:151], v[8:11], v[12:15], v[136:151]
    s_add_u32 s58, s60, 16384
    s_add_u32 s59, s62, 512
    buffer_load_dwordx4 v[8:11], v1, s[4:7], s58 offen sc1
    buffer_load_dwordx4 v[12:15], v2, s[8:11], s59 offen
    s_waitcnt vmcnt(30)
    v_mfma_f32_32x32x16_bf16 v[136:151], v[16:19], v[20:23], v[136:151]
    s_add_u32 s58, s60, 17408
    s_add_u32 s59, s62, 544
    buffer_load_dwordx4 v[16:19], v1, s[4:7], s58 offen sc1
    buffer_load_dwordx4 v[20:23], v2, s[8:11], s59 offen
    s_waitcnt vmcnt(30)
    v_mfma_f32_32x32x16_bf16 v[136:151], v[24:27], v[28:31], v[136:151]
    s_add_u32 s58, s60, 18432
    s_add_u32 s59, s62, 576
    buffer_load_dwordx4 v[24:27], v1, s[4:7], s58 offen sc1
    buffer_load_dwordx4 v[28:31], v2, s[8:11], s59 offen
    s_waitcnt vmcnt(30)
    v_mfma_f32_32x32x16_bf16 v[136:151], v[32:35], v[36:39], v[136:151]
    s_add_u32 s58, s60, 19456
    s_add_u32 s59, s62, 608
    buffer_load_dwordx4 v[32:35], v1, s[4:7], s58 offen sc1
    buffer_load_dwordx4 v[36:39], v2, s[8:11], s59 offen
    s_waitcnt vmcnt(30)
    v_mfma_f32_32x32x16_bf16 v[136:151], v[40:43], v[44:47], v[136:151]
    s_add_u32 s58, s60, 20480
    s_add_u32 s59, s62, 640
    buffer_load_dwordx4 v[40:43], v1, s[4:7], s58 offen sc1
    buffer_load_dwordx4 v[44:47], v2, s[8:11], s59 offen
    s_waitcnt vmcnt(30)
    v_mfma_f32_32x32x16_bf16 v[136:151], v[48:51], v[52:55], v[136:151]
    s_add_u32 s58, s60, 21504
    s_add_u32 s59, s62, 672
    buffer_load_dwordx4 v[48:51], v1, s[4:7], s58 offen sc1
    buffer_load_dwordx4 v[52:55], v2, s[8:11], s59 offen
    s_waitcnt vmcnt(30)
    v_mfma_f32_32x32x16_bf16 v[136:151], v[56:59], v[60:63], v[136:151]
    s_add_u32 s58, s60, 22528
    s_add_u32 s59, s62, 704
    buffer_load_dwordx4 v[56:59], v1, s[4:7], s58 offen sc1
    buffer_load_dwordx4 v[60:63], v2, s[8:11], s59 offen
    s_waitcnt vmcnt(30)
    v_mfma_f32_32x32x16_bf16 v[136:151], v[64:67], v[68:71], v[136:151]
    s_add_u32 s58, s60, 23552
    s_add_u32 s59, s62, 736
    buffer_load_dwordx4 v[64:67], v1, s[4:7], s58 offen sc1
    buffer_load_dwordx4 v[68:71], v2, s[8:11], s59 offen
    s_waitcnt vmcnt(30)
    v_mfma_f32_32x32x16_bf16 v[136:151], v[72:75], v[76:79], v[136:151]
    s_add_u32 s58, s60, 24576
    s_add_u32 s59, s62, 768
    buffer_load_dwordx4 v[72:75], v1, s[4:7], s58 offen sc1
    buffer_load_dwordx4 v[76:79], v2, s[8:11], s59 offen
    s_waitcnt vmcnt(30)
    v_mfma_f32_32x32x16_bf16 v[136:151], v[80:83], v[84:87], v[136:151]
    s_add_u32 s58, s60, 25600
    s_add_u32 s59, s62, 800
    buffer_load_dwordx4 v[80:83], v1, s[4:7], s58 offen sc1
    buffer_load_dwordx4 v[84:87], v2, s[8:11], s59 offen
    s_waitcnt vmcnt(30)
    v_mfma_f32_32x32x16_bf16 v[136:151], v[88:91], v[92:95], v[136:151]
    s_add_u32 s58, s60, 26624
    s_add_u32 s59, s62, 832
    buffer_load_dwordx4 v[88:91], v1, s[4:7], s58 offen sc1
    buffer_load_dwordx4 v[92:95], v2, s[8:11], s59 offen
    s_waitcnt vmcnt(30)
    v_mfma_f32_32x32x16_bf16 v[136:151], v[96:99], v[100:103], v[136:151]
    s_add_u32 s58, s60, 27648
    s_add_u32 s59, s62, 864
    buffer_load_dwordx4 v[96:99], v1, s[4:7], s58 offen sc1
    buffer_load_dwordx4 v[100:103], v2, s[8:11], s59 offen
    s_waitcnt vmcnt(30)
    v_mfma_f32_32x32x16_bf16 v[136:151], v[104:107], v[108:111], v[136:151]
    s_add_u32 s58, s60, 28672
    s_add_u32 s59, s62, 896
    buffer_load_dwordx4 v[104:107], v1, s[4:7], s58 offen sc1
    buffer_load_dwordx4 v[108:111], v2, s[8:11], s59 offen
    s_waitcnt vmcnt(30)
    v_mfma_f32_32x32x16_bf16 v[136:151], v[112:115], v[116:119], v[136:151]
    s_add_u32 s58, s60, 29696
    s_add_u32 s59, s62, 928
    buffer_load_dwordx4 v[112:115], v1, s[4:7], s58 offen sc1
    buffer_load_dwordx4 v[116:119], v2, s[8:11], s59 offen
    s_waitcnt vmcnt(30)
    v_mfma_f32_32x32x16_bf16 v[136:151], v[120:123], v[124:127], v[136:151]
    s_add_u32 s58, s60, 30720
    s_add_u32 s59, s62, 960
    buffer_load_dwordx4 v[120:123], v1, s[4:7], s58 offen sc1
    buffer_load_dwordx4 v[124:127], v2, s[8:11], s59 offen
    s_waitcnt vmcnt(30)
    v_mfma_f32_32x32x16_bf16 v[136:151], v[128:131], v[132:135], v[136:151]
    s_add_u32 s58, s60, 31744
    s_add_u32 s59, s62, 992
    buffer_load_dwordx4 v[128:131], v1, s[4:7], s58 offen sc1
    buffer_load_dwordx4 v[132:135], v2, s[8:11], s59 offen
    s_waitcnt vmcnt(30)
    v_mfma_f32_32x32x16_bf16 v[136:151], v[8:11], v[12:15], v[136:151]
    s_waitcnt vmcnt(28)
    v_mfma_f32_32x32x16_bf16 v[136:151], v[16:19], v[20:23], v[136:151]
    s_waitcnt vmcnt(26)
    v_mfma_f32_32x32x16_bf16 v[136:151], v[24:27], v[28:31], v[136:151]
    s_waitcnt vmcnt(24)
    v_mfma_f32_32x32x16_bf16 v[136:151], v[32:35], v[36:39], v[136:151]
    s_waitcnt vmcnt(22)
    v_mfma_f32_32x32x16_bf16 v[136:151], v[40:43], v[44:47], v[136:151]
    s_waitcnt vmcnt(20)
    v_mfma_f32_32x32x16_bf16 v[136:151], v[48:51], v[52:55], v[136:151]
    s_waitcnt vmcnt(18)
    v_mfma_f32_32x32x16_bf16 v[136:151], v[56:59], v[60:63], v[136:151]
    s_waitcnt vmcnt(16)
    v_mfma_f32_32x32x16_bf16 v[136:151], v[64:67], v[68:71], v[136:151]
    s_waitcnt vmcnt(14)
    v_mfma_f32_32x32x16_bf16 v[136:151], v[72:75], v[76:79], v[136:151]
    s_waitcnt vmcnt(12)
    v_mfma_f32_32x32x16_bf16 v[136:151], v[80:83], v[84:87], v[136:151]
    s_waitcnt vmcnt(10)
    v_mfma_f32_32x32x16_bf16 v[136:151], v[88:91], v[92:95], v[136:151]
    s_waitcnt vmcnt(8)
    v_mfma_f32_32x32x16_bf16 v[136:151], v[96:99], v[100:103], v[136:151]
    s_waitcnt vmcnt(6)
    v_mfma_f32_32x32x16_bf16 v[136:151], v[104:107], v[108:111], v[136:151]
    s_waitcnt vmcnt(4)
    v_mfma_f32_32x32x16_bf16 v[136:151], v[112:115], v[116:119], v[136:151]
    s_waitcnt vmcnt(2)
    v_mfma_f32_32x32x16_bf16 v[136:151], v[120:123], v[124:127], v[136:151]
    s_waitcnt vmcnt(0)
    v_mfma_f32_32x32x16_bf16 v[136:151], v[128:131], v[132:135], v[136:151]
    s_nop 15
    s_cmp_eq_u32 s42, 0
    s_cbranch_scc1 K2_COMBA
    s_lshl_b32 s56, s42, 12
    s_add_u32 s56, s56, 126976
    v_add_u32 v5, s56, v1
    ds_write_b128 v5, v[136:139] offset:0
    ds_write_b128 v5, v[140:143] offset:1024
    ds_write_b128 v5, v[144:147] offset:2048
    ds_write_b128 v5, v[148:151] offset:3072
    v_mov_b32 v6, 163456
    v_mov_b32 v7, 1
    s_waitcnt lgkmcnt(0)
    s_mov_b64 exec, 1
    ds_add_u32 v6, v7
    s_waitcnt lgkmcnt(0)
    s_mov_b64 exec, -1
    s_branch K2_JOBDONEA
K2_COMBA:
    v_lshrrev_b32 v4, 5, v0
    v_lshlrev_b32 v4, 4, v4
    s_lshl_b32 s56, s41, 7
    s_add_u32 s57, s56, 0x720000
    buffer_load_dwordx4 v[8:11], v4, s[4:7], s57 offen offset:0 sc1
    buffer_load_dwordx4 v[12:15], v4, s[4:7], s57 offen offset:32 sc1
    buffer_load_dwordx4 v[16:19], v4, s[4:7], s57 offen offset:64 sc1
    buffer_load_dwordx4 v[20:23], v4, s[4:7], s57 offen offset:96 sc1
    v_mov_b32 v6, 163456
K2_SPINA:
    ds_read_b32 v7, v6
    s_waitcnt lgkmcnt(0)
    v_readfirstlane_b32 s57, v7
    s_cmp_eq_u32 s57, 3
    s_cbranch_scc1 K2_GOA
    s_sleep 4
    s_sub_u32 s67, s67, 1
    s_cmp_gt_i32 s67, 0
    s_cbranch_scc1 K2_SPINA
K2_GOA:
    v_add_u32 v5, 131072, v1
    ds_read_b128 v[24:27], v5 offset:0
    ds_read_b128 v[28:31], v5 offset:1024
    ds_read_b128 v[32:35], v5 offset:2048
    ds_read_b128 v[36:39], v5 offset:3072
    ds_read_b128 v[40:43], v5 offset:4096
    ds_read_b128 v[44:47], v5 offset:5120
    ds_read_b128 v[48:51], v5 offset:6144
    ds_read_b128 v[52:55], v5 offset:7168
    ds_read_b128 v[56:59], v5 offset:8192
    ds_read_b128 v[60:63], v5 offset:9216
    ds_read_b128 v[64:67], v5 offset:10240
    ds_read_b128 v[68:71], v5 offset:11264
    v_and_b32 v6, 1, v0
    v_lshlrev_b32 v6, 31, v6
    v_or_b32 v6, 1.0, v6
    s_movk_i32 s58, 1152
    v_mul_lo_u32 v7, v3, s58
    v_add_u32 v7, v7, v4
    s_waitcnt vmcnt(0) lgkmcnt(0)
    v_mov_b32 v5, 163464
    v_mov_b32 v4, 1
    ds_write_b32 v5, v4
    v_fmac_f32 v136, v6, v8
    v_fmac_f32 v137, v6, v9
    v_fmac_f32 v138, v6, v10
    v_fmac_f32 v139, v6, v11
    v_fmac_f32 v140, v6, v12
    v_fmac_f32 v141, v6, v13
    v_fmac_f32 v142, v6, v14
    v_fmac_f32 v143, v6, v15
    v_fmac_f32 v144, v6, v16
    v_fmac_f32 v145, v6, v17
    v_fmac_f32 v146, v6, v18
    v_fmac_f32 v147, v6, v19
    v_fmac_f32 v148, v6, v20
    v_fmac_f32 v149, v6, v21
    v_fmac_f32 v150, v6, v22
    v_fmac_f32 v151, v6, v23
    v_add_f32 v136, v136, v24
    v_add_f32 v137, v137, v25
    v_add_f32 v138, v138, v26
    v_add_f32 v139, v139, v27
    v_add_f32 v140, v140, v28
    v_add_f32 v141, v141, v29
    v_add_f32 v142, v142, v30
    v_add_f32 v143, v143, v31
    v_add_f32 v144, v144, v32
    v_add_f32 v145, v145, v33
    v_add_f32 v146, v146, v34
    v_add_f32 v147, v147, v35
    v_add_f32 v148, v148, v36
    v_add_f32 v149, v149, v37
    v_add_f32 v150, v150, v38
    v_add_f32 v151, v151, v39
    v_add_f32 v40, v40, v56
    v_add_f32 v41, v41, v57
    v_add_f32 v42, v42, v58
    v_add_f32 v43, v43, v59
    v_add_f32 v44, v44, v60
    v_add_f32 v45, v45, v61
    v_add_f32 v46, v46, v62
    v_add_f32 v47, v47, v63
    v_add_f32 v48, v48, v64
    v_add_f32 v49, v49, v65
    v_add_f32 v50, v50, v66
    v_add_f32 v51, v51, v67
    v_add_f32 v52, v52, v68
    v_add_f32 v53, v53, v69
    v_add_f32 v54, v54, v70
    v_add_f32 v55, v55, v71
    v_sub_f32 v24, v136, v40
    v_add_f32 v56, v136, v40
    v_sub_f32 v25, v137, v41
    v_add_f32 v57, v137, v41
    v_sub_f32 v26, v138, v42
    v_add_f32 v58, v138, v42
    v_sub_f32 v27, v139, v43
    v_add_f32 v59, v139, v43
    v_sub_f32 v28, v140, v44
    v_add_f32 v60, v140, v44
    v_sub_f32 v29, v141, v45
    v_add_f32 v61, v141, v45
    v_sub_f32 v30, v142, v46
    v_add_f32 v62, v142, v46
    v_sub_f32 v31, v143, v47
    v_add_f32 v63, v143, v47
    v_sub_f32 v32, v144, v48
    v_add_f32 v64, v144, v48
    v_sub_f32 v33, v145, v49
    v_add_f32 v65, v145, v49
    v_sub_f32 v34, v146, v50
    v_add_f32 v66, v146, v50
    v_sub_f32 v35, v147, v51
    v_add_f32 v67, v147, v51
    v_sub_f32 v36, v148, v52
    v_add_f32 v68, v148, v52
    v_sub_f32 v37, v149, v53
    v_add_f32 v69, v149, v53
    v_sub_f32 v38, v150, v54
    v_add_f32 v70, v150, v54
    v_sub_f32 v39, v151, v55
    v_add_f32 v71, v151, v55
    s_mul_i32 s57, s40, 9
    s_add_u32 s57, s57, s41
    s_lshl_b32 s57, s57, 13
    s_add_u32 s57, s57, 0xa00000
    s_add_u32 s58, s57, 4096
    buffer_store_dwordx4 v[24:27], v1, s[4:7], s57 offen offset:0 sc1
    buffer_store_dwordx4 v[56:59], v1, s[4:7], s58 offen offset:0 sc1
    buffer_store_dwordx4 v[28:31], v1, s[4:7], s57 offen offset:1024 sc1
    buffer_store_dwordx4 v[60:63], v1, s[4:7], s58 offen offset:1024 sc1
    buffer_store_dwordx4 v[32:35], v1, s[4:7], s57 offen offset:2048 sc1
    buffer_store_dwordx4 v[64:67], v1, s[4:7], s58 offen offset:2048 sc1
    buffer_store_dwordx4 v[36:39], v1, s[4:7], s57 offen offset:3072 sc1
    buffer_store_dwordx4 v[68:71], v1, s[4:7], s58 offen offset:3072 sc1
K2_JOBDONEA:
    s_mov_b32 s16, s28
    s_and_b32 s17, s29, 0xffff
    s_mov_b32 s18, 0x80000
    s_mov_b32 s19, 0x20000
    s_lshl_b32 s56, s42, 7
    v_add_u32 v5, s56, v0
    v_lshlrev_b32 v5, 10, v5
    s_lshl_b32 s57, s41, 7
    buffer_load_dword v6, v5, s[16:19], s57 offen
    buffer_load_dword v6, v5, s[16:19], s57 offen offset:64
    s_add_u32 s57, s57, 65536
    buffer_load_dword v7, v5, s[16:19], s57 offen
    buffer_load_dword v7, v5, s[16:19], s57 offen offset:64
    s_cmp_ge_u32 s2, 41
    s_cbranch_scc1 K2_FEND
    s_sub_u32 s64, s2, 32
    s_cmp_lt_u32 s2, 32
    s_cselect_b32 s63, s2, 32
    s_cselect_b32 s64, 8, s64
    s_waitcnt vmcnt(0)
    s_lshl_b32 s56, s63, 5
    v_and_b32 v2, 31, v0
    v_add_u32 v3, s56, v2
    v_lshlrev_b32 v2, 12, v3
    v_lshrrev_b32 v4, 5, v0
    v_lshl_add_u32 v2, v4, 4, v2
    s_lshl_b32 s57, s42, 4
    s_mov_b32 s8, s24
    s_mov_b32 s9, s25
    s_mov_b32 s58, 0x600000
    s_and_b32 s9, s9, 0xffff
    s_mov_b32 s10, 0x800000
    s_mov_b32 s11, 0x20000
    s_lshl_b32 s56, s64, 16
    s_add_u32 s60, s56, s58
    s_lshl_b32 s56, s57, 10
    s_add_u32 s60, s60, s56
    s_lshl_b32 s62, s57, 5
    s_add_u32 s58, s60, 0
    s_add_u32 s59, s62, 0
    buffer_load_dwordx4 v[8:11], v1, s[4:7], s58 offen sc1
    buffer_load_dwordx4 v[12:15], v2, s[8:11], s59 offen
    s_add_u32 s58, s60, 1024
    s_add_u32 s59, s62, 32
    buffer_load_dwordx4 v[16:19], v1, s[4:7], s58 offen sc1
    buffer_load_dwordx4 v[20:23], v2, s[8:11], s59 offen
    s_add_u32 s58, s60, 2048
    s_add_u32 s59, s62, 64
    buffer_load_dwordx4 v[24:27], v1, s[4:7], s58 offen sc1
    buffer_load_dwordx4 v[28:31], v2, s[8:11], s59 offen
    s_add_u32 s58, s60, 3072
    s_add_u32 s59, s62, 96
    buffer_load_dwordx4 v[32:35], v1, s[4:7], s58 offen sc1
    buffer_load_dwordx4 v[36:39], v2, s[8:11], s59 offen
    s_add_u32 s58, s60, 4096
    s_add_u32 s59, s62, 128
    buffer_load_dwordx4 v[40:43], v1, s[4:7], s58 offen sc1
    buffer_load_dwordx4 v[44:47], v2, s[8:11], s59 offen
    s_add_u32 s58, s60, 5120
    s_add_u32 s59, s62, 160
    buffer_load_dwordx4 v[48:51], v1, s[4:7], s58 offen sc1
    buffer_load_dwordx4 v[52:55], v2, s[8:11], s59 offen
    s_add_u32 s58, s60, 6144
    s_add_u32 s59, s62, 192
    buffer_load_dwordx4 v[56:59], v1, s[4:7], s58 offen sc1
    buffer_load_dwordx4 v[60:63], v2, s[8:11], s59 offen
    s_add_u32 s58, s60, 7168
    s_add_u32 s59, s62, 224
    buffer_load_dwordx4 v[64:67], v1, s[4:7], s58 offen sc1
    buffer_load_dwordx4 v[68:71], v2, s[8:11], s59 offen
    s_add_u32 s58, s60, 8192
    s_add_u32 s59, s62, 256
    buffer_load_dwordx4 v[72:75], v1, s[4:7], s58 offen sc1
    buffer_load_dwordx4 v[76:79], v2, s[8:11], s59 offen
    s_add_u32 s58, s60, 9216
    s_add_u32 s59, s62, 288
    buffer_load_dwordx4 v[80:83], v1, s[4:7], s58 offen sc1
    buffer_load_dwordx4 v[84:87], v2, s[8:11], s59 offen
    s_add_u32 s58, s60, 10240
    s_add_u32 s59, s62, 320
    buffer_load_dwordx4 v[88:91], v1, s[4:7], s58 offen sc1
    buffer_load_dwordx4 v[92:95], v2, s[8:11], s59 offen
    s_add_u32 s58, s60, 11264
    s_add_u32 s59, s62, 352
    buffer_load_dwordx4 v[96:99], v1, s[4:7], s58 offen sc1
    buffer_load_dwordx4 v[100:103], v2, s[8:11], s59 offen
    s_add_u32 s58, s60, 12288
    s_add_u32 s59, s62, 384
    buffer_load_dwordx4 v[104:107], v1, s[4:7], s58 offen sc1
    buffer_load_dwordx4 v[108:111], v2, s[8:11], s59 offen
    s_add_u32 s58, s60, 13312
    s_add_u32 s59, s62, 416
    buffer_load_dwordx4 v[112:115], v1, s[4:7], s58 offen sc1
    buffer_load_dwordx4 v[116:119], v2, s[8:11], s59 offen
    s_add_u32 s58, s60, 14336
    s_add_u32 s59, s62, 448
    buffer_load_dwordx4 v[120:123], v1, s[4:7], s58 offen sc1
    buffer_load_dwordx4 v[124:127], v2, s[8:11], s59 offen
    s_add_u32 s58, s60, 15360
    s_add_u32 s59, s62, 480
    buffer_load_dwordx4 v[128:131], v1, s[4:7], s58 offen sc1
    buffer_load_dwordx4 v[132:135], v2, s[8:11], s59 offen
    v_mov_b32 v136, 0
    v_mov_b32 v137, 0
    v_mov_b32 v138, 0
    v_mov_b32 v139, 0
    v_mov_b32 v140, 0
    v_mov_b32 v141, 0
    v_mov_b32 v142, 0
    v_mov_b32 v143, 0
    v_mov_b32 v144, 0
    v_mov_b32 v145, 0
    v_mov_b32 v146, 0
    v_mov_b32 v147, 0
    v_mov_b32 v148, 0
    v_mov_b32 v149, 0
    v_mov_b32 v150, 0
    v_mov_b32 v151, 0
    s_waitcnt vmcnt(30)
    v_mfma_f32_32x32x16_bf16 v[136:151], v[8:11], v[12:15], v[136:151]
    s_waitcnt vmcnt(28)
    v_mfma_f32_32x32x16_bf16 v[136:151], v[16:19], v[20:23], v[136:151]
    s_waitcnt vmcnt(26)
    v_mfma_f32_32x32x16_bf16 v[136:151], v[24:27], v[28:31], v[136:151]
    s_waitcnt vmcnt(24)
    v_mfma_f32_32x32x16_bf16 v[136:151], v[32:35], v[36:39], v[136:151]
    s_waitcnt vmcnt(22)
    v_mfma_f32_32x32x16_bf16 v[136:151], v[40:43], v[44:47], v[136:151]
    s_waitcnt vmcnt(20)
    v_mfma_f32_32x32x16_bf16 v[136:151], v[48:51], v[52:55], v[136:151]
    s_waitcnt vmcnt(18)
    v_mfma_f32_32x32x16_bf16 v[136:151], v[56:59], v[60:63], v[136:151]
    s_waitcnt vmcnt(16)
    v_mfma_f32_32x32x16_bf16 v[136:151], v[64:67], v[68:71], v[136:151]
    s_waitcnt vmcnt(14)
    v_mfma_f32_32x32x16_bf16 v[136:151], v[72:75], v[76:79], v[136:151]
    s_waitcnt vmcnt(12)
    v_mfma_f32_32x32x16_bf16 v[136:151], v[80:83], v[84:87], v[136:151]
    s_waitcnt vmcnt(10)
    v_mfma_f32_32x32x16_bf16 v[136:151], v[88:91], v[92:95], v[136:151]
    s_waitcnt vmcnt(8)
    v_mfma_f32_32x32x16_bf16 v[136:151], v[96:99], v[100:103], v[136:151]
    s_waitcnt vmcnt(6)
    v_mfma_f32_32x32x16_bf16 v[136:151], v[104:107], v[108:111], v[136:151]
    s_waitcnt vmcnt(4)
    v_mfma_f32_32x32x16_bf16 v[136:151], v[112:115], v[116:119], v[136:151]
    s_waitcnt vmcnt(2)
    v_mfma_f32_32x32x16_bf16 v[136:151], v[120:123], v[124:127], v[136:151]
    s_waitcnt vmcnt(0)
    v_mfma_f32_32x32x16_bf16 v[136:151], v[128:131], v[132:135], v[136:151]
    s_nop 15
    s_cmp_eq_u32 s42, 0
    s_cbranch_scc1 K2_COMBB
    v_mov_b32 v6, 163464
K2_SPINC:
    ds_read_b32 v7, v6
    s_waitcnt lgkmcnt(0)
    v_readfirstlane_b32 s57, v7
    s_cmp_eq_u32 s57, 1
    s_cbranch_scc1 K2_GOC
    s_sleep 4
    s_sub_u32 s67, s67, 1
    s_cmp_gt_i32 s67, 0
    s_cbranch_scc1 K2_SPINC
K2_GOC:
    s_lshl_b32 s56, s42, 12
    s_add_u32 s56, s56, 126976
    v_add_u32 v5, s56, v1
    ds_write_b128 v5, v[136:139] offset:0
    ds_write_b128 v5, v[140:143] offset:1024
    ds_write_b128 v5, v[144:147] offset:2048
    ds_write_b128 v5, v[148:151] offset:3072
    v_mov_b32 v6, 163460
    v_mov_b32 v7, 1
    s_waitcnt lgkmcnt(0)
    s_mov_b64 exec, 1
    ds_add_u32 v6, v7
    s_waitcnt lgkmcnt(0)
    s_mov_b64 exec, -1
    s_branch K2_JOBDONEB
K2_COMBB:
    v_lshrrev_b32 v4, 5, v0
    v_lshlrev_b32 v4, 4, v4
    s_lshl_b32 s56, s64, 7
    s_add_u32 s57, s56, 0x720000
    buffer_load_dwordx4 v[8:11], v4, s[4:7], s57 offen offset:0 sc1
    buffer_load_dwordx4 v[12:15], v4, s[4:7], s57 offen offset:32 sc1
    buffer_load_dwordx4 v[16:19], v4, s[4:7], s57 offen offset:64 sc1
    buffer_load_dwordx4 v[20:23], v4, s[4:7], s57 offen offset:96 sc1
    v_mov_b32 v6, 163460
K2_SPINB:
    ds_read_b32 v7, v6
    s_waitcnt lgkmcnt(0)
    v_readfirstlane_b32 s57, v7
    s_cmp_eq_u32 s57, 3
    s_cbranch_scc1 K2_GOB
    s_sleep 4
    s_sub_u32 s67, s67, 1
    s_cmp_gt_i32 s67, 0
    s_cbranch_scc1 K2_SPINB
K2_GOB:
    v_add_u32 v5, 131072, v1
    ds_read_b128 v[24:27], v5 offset:0
    ds_read_b128 v[28:31], v5 offset:1024
    ds_read_b128 v[32:35], v5 offset:2048
    ds_read_b128 v[36:39], v5 offset:3072
    ds_read_b128 v[40:43], v5 offset:4096
    ds_read_b128 v[44:47], v5 offset:5120
    ds_read_b128 v[48:51], v5 offset:6144
    ds_read_b128 v[52:55], v5 offset:7168
    ds_read_b128 v[56:59], v5 offset:8192
    ds_read_b128 v[60:63], v5 offset:9216
    ds_read_b128 v[64:67], v5 offset:10240
    ds_read_b128 v[68:71], v5 offset:11264
    v_and_b32 v6, 1, v0
    v_lshlrev_b32 v6, 31, v6
    v_or_b32 v6, 1.0, v6
    s_movk_i32 s58, 1152
    v_mul_lo_u32 v7, v3, s58
    v_add_u32 v7, v7, v4
    s_waitcnt vmcnt(0) lgkmcnt(0)
    v_fmac_f32 v136, v6, v8
    v_fmac_f32 v137, v6, v9
    v_fmac_f32 v138, v6, v10
    v_fmac_f32 v139, v6, v11
    v_fmac_f32 v140, v6, v12
    v_fmac_f32 v141, v6, v13
    v_fmac_f32 v142, v6, v14
    v_fmac_f32 v143, v6, v15
    v_fmac_f32 v144, v6, v16
    v_fmac_f32 v145, v6, v17
    v_fmac_f32 v146, v6, v18
    v_fmac_f32 v147, v6, v19
    v_fmac_f32 v148, v6, v20
    v_fmac_f32 v149, v6, v21
    v_fmac_f32 v150, v6, v22
    v_fmac_f32 v151, v6, v23
    v_add_f32 v136, v136, v24
    v_add_f32 v137, v137, v25
    v_add_f32 v138, v138, v26
    v_add_f32 v139, v139, v27
    v_add_f32 v140, v140, v28
    v_add_f32 v141, v141, v29
    v_add_f32 v142, v142, v30
    v_add_f32 v143, v143, v31
    v_add_f32 v144, v144, v32
    v_add_f32 v145, v145, v33
    v_add_f32 v146, v146, v34
    v_add_f32 v147, v147, v35
    v_add_f32 v148, v148, v36
    v_add_f32 v149, v149, v37
    v_add_f32 v150, v150, v38
    v_add_f32 v151, v151, v39
    v_add_f32 v40, v40, v56
    v_add_f32 v41, v41, v57
    v_add_f32 v42, v42, v58
    v_add_f32 v43, v43, v59
    v_add_f32 v44, v44, v60
    v_add_f32 v45, v45, v61
    v_add_f32 v46, v46, v62
    v_add_f32 v47, v47, v63
    v_add_f32 v48, v48, v64
    v_add_f32 v49, v49, v65
    v_add_f32 v50, v50, v66
    v_add_f32 v51, v51, v67
    v_add_f32 v52, v52, v68
    v_add_f32 v53, v53, v69
    v_add_f32 v54, v54, v70
    v_add_f32 v55, v55, v71
    v_add_f32 v136, v136, v40
    v_add_f32 v137, v137, v41
    v_add_f32 v138, v138, v42
    v_add_f32 v139, v139, v43
    v_add_f32 v140, v140, v44
    v_add_f32 v141, v141, v45
    v_add_f32 v142, v142, v46
    v_add_f32 v143, v143, v47
    v_add_f32 v144, v144, v48
    v_add_f32 v145, v145, v49
    v_add_f32 v146, v146, v50
    v_add_f32 v147, v147, v51
    v_add_f32 v148, v148, v52
    v_add_f32 v149, v149, v53
    v_add_f32 v150, v150, v54
    v_add_f32 v151, v151, v55
    s_mul_i32 s57, s63, 9
    s_add_u32 s57, s57, s64
    s_lshl_b32 s57, s57, 13
    s_add_u32 s57, s57, 0xa00000
    s_add_u32 s58, s57, 4096
    buffer_store_dwordx4 v[136:139], v1, s[4:7], s57 offen offset:0 sc1
    buffer_store_dwordx4 v[136:139], v1, s[4:7], s58 offen offset:0 sc1
    buffer_store_dwordx4 v[140:143], v1, s[4:7], s57 offen offset:1024 sc1
    buffer_store_dwordx4 v[140:143], v1, s[4:7], s58 offen offset:1024 sc1
    buffer_store_dwordx4 v[144:147], v1, s[4:7], s57 offen offset:2048 sc1
    buffer_store_dwordx4 v[144:147], v1, s[4:7], s58 offen offset:2048 sc1
    buffer_store_dwordx4 v[148:151], v1, s[4:7], s57 offen offset:3072 sc1
    buffer_store_dwordx4 v[148:151], v1, s[4:7], s58 offen offset:3072 sc1
K2_JOBDONEB:
K2_FEND:
K2_PHASE3:
    s_waitcnt vmcnt(0)
    s_cmp_eq_u32 s36, 8
    s_cbranch_scc0 K2_PHASE3B
    s_lshl_b32 s52, s2, 7
    s_add_u32 s52, s52, 0x730000
    v_mov_b32 v2, s65
    v_mov_b32 v3, 0
    s_mov_b64 exec, 1
    buffer_store_dword v2, v3, s[4:7], s52 offen sc1
    s_mov_b64 exec, -1
K2_PHASE3B:
    s_barrier
    s_cmp_lt_u32 s36, 8
    s_cbranch_scc1 K3_COMPUTE
    s_cmp_eq_u32 s36, 8
    s_cbranch_scc0 K3_WO
    s_mov_b32 s50, s65
    v_lshrrev_b32 v4, 1, v0
    v_lshlrev_b32 v4, 5, v4
    v_add_u32 v4, s40, v4
    v_lshlrev_b32 v4, 7, v4
    v_and_b32 v5, 1, v0
    v_lshl_add_u32 v4, v5, 2, v4
    s_and_b32 s54, s40, 3
    s_lshr_b32 s55, s40, 2
    v_lshlrev_b32 v6, 2, v0
    v_add_u32 v6, s54, v6
    v_lshlrev_b32 v6, 3, v6
    v_add_u32 v6, s55, v6
    v_add_u32 v7, 23, v0
    v_cmp_lt_u32 vcc, 8, v0
    s_cmp_eq_u32 s40, 0
    s_cselect_b32 s55, 17, 8
    v_cndmask_b32 v6, v6, v7, vcc
    v_mov_b32 v8, s40
    v_cmp_eq_u32 vcc, 8, v0
    s_nop 1
    v_cndmask_b32 v6, v6, v8, vcc
    v_cmp_lt_u32 vcc, s55, v0
    s_nop 1
    v_cndmask_b32 v6, v6, v8, vcc
    v_lshlrev_b32 v6, 7, v6
    s_mov_b32 s52, 0x740000
    s_mov_b32 s53, 0x730000
    s_mov_b32 s51, 0
    s_sleep 8
K3_POLL:
    buffer_load_dword v5, v4, s[4:7], s52 offen sc1
    buffer_load_dword v7, v6, s[4:7], s53 offen sc1
    s_waitcnt vmcnt(0)
    v_xor_b32 v5, s50, v5
    v_xor_b32 v7, s50, v7
    v_or_b32 v5, v5, v7
    v_cmp_ne_u32 vcc, 0, v5
    s_add_u32 s51, s51, 1
    s_nop 3
    s_cmp_eq_u64 vcc, 0
    s_cbranch_scc1 K3_JOIN
    s_sleep 4
    s_cmp_lt_u32 s51, 0x40000
    s_cbranch_scc1 K3_POLL
K3_JOIN:
    s_barrier
K2_END:
    s_endpgm
K3_WO:
    s_mov_b32 s8, s28
    s_and_b32 s9, s29, 0xffff
    s_mov_b32 s10, 0x80000
    s_mov_b32 s11, 0x20000
    s_sub_u32 s42, s36, 9
    v_lshrrev_b32 v9, 3, v0
    v_and_b32 v11, 7, v0
    v_bfe_u32 v13, v9, 1, 1
    v_lshlrev_b32 v13, 2, v13
    v_xor_b32 v13, v11, v13
    v_lshlrev_b32 v13, 4, v13
    v_lshlrev_b32 v9, 10, v9
    s_lshl_b32 s45, s41, 7
    v_add3_u32 v2, v9, v13, s45
K3_WOL:
    s_lshl_b32 m0, s42, 10
    s_lshl_b32 s49, s42, 13
    buffer_load_dwordx4 v2, s[8:11], s49 offen lds
    s_add_u32 s42, s42, 3
    s_cmp_lt_u32 s42, 64
    s_cbranch_scc1 K3_WOL
    s_waitcnt vmcnt(0)
    s_branch K3_JOIN
K3_COMPUTE:
    s_mov_b32 s8, s84
    s_and_b32 s9, s85, 0xffff
    s_mov_b32 s10, 0x200000
    s_mov_b32 s11, 0x20000
    s_and_b32 s42, s36, 1
    s_lshr_b32 s44, s36, 1
    s_lshr_b32 s43, s44, 1
    s_and_b32 s45, s44, 1
    v_and_b32 v8, 31, v0
    v_and_b32 v9, 19, v8
    v_bfe_u32 v10, v8, 2, 1
    v_lshl_or_b32 v9, v10, 3, v9
    v_bfe_u32 v10, v8, 3, 1
    v_lshl_or_b32 v9, v10, 2, v9
    s_lshl_b32 s46, s40, 5
    v_add_u32 v9, s46, v9
    v_sub_u32 v10, 0x800, v9
    v_mov_b32 v11, 0x400
    v_cmp_eq_u32 vcc, 0, v9
    s_cmp_eq_u32 s42, 1
    s_cselect_b64 s[46:47], -1, 0
    v_cndmask_b32 v10, v10, v11, vcc
    v_cndmask_b32 v11, v9, v11, vcc
    v_cndmask_b32 v12, v9, v10, s[46:47]
    v_cndmask_b32 v13, v9, v11, s[46:47]
    v_lshrrev_b32 v14, 5, v0
    v_lshlrev_b32 v15, 2, v12
    s_mov_b32 s48, 0x721000
    buffer_load_dword v55, v15, s[4:7], s48 offen sc1
    s_lshl_b32 s49, s41, 6
    s_lshl_b32 s50, s43, 5
    s_add_u32 s49, s49, s50
    s_lshl_b32 s50, s45, 3
    s_add_u32 s49, s49, s50
    v_lshlrev_b32 v6, 4, v14
    v_add_u32 v6, s49, v6
    v_lshlrev_b32 v4, 10, v12
    v_lshl_add_u32 v4, v6, 1, v4
    s_lshr_b32 s50, s41, 2
    s_xor_b32 s51, s50, s42
    v_sub_u32 v7, 505, v6
    s_cmp_eq_u32 s50, 1
    s_cselect_b64 s[54:55], -1, 0
    v_cndmask_b32 v7, v6, v7, s[54:55]
    v_lshrrev_b32 v7, 2, v7
    v_lshrrev_b32 v15, 5, v13
    v_mul_u32_u24 v15, 18, v15
    v_add_u32 v15, s51, v15
    v_lshlrev_b32 v15, 12, v15
    v_and_b32 v5, 31, v13
    v_lshl_add_u32 v15, v5, 4, v15
    v_add_u32 v5, 0, v7
    v_lshrrev_b32 v10, 3, v5
    v_lshlrev_b32 v10, 13, v10
    v_bfe_u32 v11, v5, 1, 2
    v_lshl_add_u32 v10, v11, 10, v10
    v_and_b32 v11, 1, v5
    v_lshl_add_u32 v10, v11, 9, v10
    v_add_u32 v50, v10, v15
    v_add_u32 v5, 1, v7
    v_lshrrev_b32 v10, 3, v5
    v_lshlrev_b32 v10, 13, v10
    v_bfe_u32 v11, v5, 1, 2
    v_lshl_add_u32 v10, v11, 10, v10
    v_and_b32 v11, 1, v5
    v_lshl_add_u32 v10, v11, 9, v10
    v_add_u32 v51, v10, v15
    v_add_u32 v5, 2, v7
    v_lshrrev_b32 v10, 3, v5
    v_lshlrev_b32 v10, 13, v10
    v_bfe_u32 v11, v5, 1, 2
    v_lshl_add_u32 v10, v11, 10, v10
    v_and_b32 v11, 1, v5
    v_lshl_add_u32 v10, v11, 9, v10
    v_add_u32 v52, v10, v15
    v_lshlrev_b32 v2, 4, v0
    v_bfe_u32 v10, v0, 2, 2
    v_lshl_add_u32 v11, v14, 2, v10
    v_lshlrev_b32 v11, 7, v11
    v_and_b32 v12, 1, v0
    v_lshlrev_b32 v12, 1, v12
    v_bfe_u32 v13, v0, 4, 1
    v_add_u32 v12, v12, v13
    v_bfe_u32 v13, v0, 3, 1
    v_lshlrev_b32 v13, 2, v13
    v_xor_b32 v12, v12, v13
    v_lshlrev_b32 v12, 4, v12
    v_bfe_u32 v13, v0, 1, 1
    v_lshlrev_b32 v13, 3, v13
    v_add3_u32 v3, v11, v12, v13
    s_lshl_b32 s48, s44, 14
    v_add_u32 v3, s48, v3
    v_xor_b32 v1, 64, v3
    v_mov_b32 v16, 0
    v_mov_b32 v17, 0
    v_mov_b32 v18, 0
    v_mov_b32 v19, 0
    v_mov_b32 v20, 0
    v_mov_b32 v21, 0
    v_mov_b32 v22, 0
    v_mov_b32 v23, 0
    v_mov_b32 v24, 0
    v_mov_b32 v25, 0
    v_mov_b32 v26, 0
    v_mov_b32 v27, 0
    v_mov_b32 v28, 0
    v_mov_b32 v29, 0
    v_mov_b32 v30, 0
    v_mov_b32 v31, 0
    v_mov_b32 v32, 0
    v_mov_b32 v33, 0
    v_mov_b32 v34, 0
    v_mov_b32 v35, 0
    v_mov_b32 v36, 0
    v_mov_b32 v37, 0
    v_mov_b32 v38, 0
    v_mov_b32 v39, 0
    v_mov_b32 v40, 0
    v_mov_b32 v41, 0
    v_mov_b32 v42, 0
    v_mov_b32 v43, 0
    v_mov_b32 v44, 0
    v_mov_b32 v45, 0
    v_mov_b32 v46, 0
    v_mov_b32 v47, 0
    s_lshl_b32 s56, s40, 11
    s_lshl_b32 s57, s42, 10
    s_add_u32 s56, s56, s57
    s_lshl_b32 s57, s44, 19
    s_add_u32 s56, s56, s57
    s_add_u32 s56, s56, 0x800000
    s_mov_b32 s52, 0xa00000
    s_barrier
    s_add_u32 s57, s56, 0
    buffer_load_dwordx4 v[72:75], v2, s[4:7], s57 offen sc1
    s_add_u32 s57, s56, 65536
    buffer_load_dwordx4 v[76:79], v2, s[4:7], s57 offen sc1
    s_add_u32 s57, s56, 131072
    buffer_load_dwordx4 v[80:83], v2, s[4:7], s57 offen sc1
    s_add_u32 s57, s56, 196608
    buffer_load_dwordx4 v[84:87], v2, s[4:7], s57 offen sc1
    s_add_u32 s57, s56, 262144
    buffer_load_dwordx4 v[88:91], v2, s[4:7], s57 offen sc1
    s_add_u32 s57, s56, 327680
    buffer_load_dwordx4 v[92:95], v2, s[4:7], s57 offen sc1
    s_add_u32 s57, s56, 393216
    buffer_load_dwordx4 v[96:99], v2, s[4:7], s57 offen sc1
    s_add_u32 s57, s56, 458752
    buffer_load_dwordx4 v[100:103], v2, s[4:7], s57 offen sc1
    buffer_load_dwordx4 v[56:59], v50, s[4:7], s52 offen sc1
    buffer_load_dwordx4 v[60:63], v51, s[4:7], s52 offen sc1
    buffer_load_dwordx4 v[64:67], v52, s[4:7], s52 offen sc1
    ds_read_b64_tr_b16 v[104:105], v3 offset:0
    ds_read_b64_tr_b16 v[106:107], v3 offset:1024
    ds_read_b64_tr_b16 v[108:109], v1 offset:0
    ds_read_b64_tr_b16 v[110:111], v1 offset:1024
    ds_read_b64_tr_b16 v[112:113], v3 offset:2048
    ds_read_b64_tr_b16 v[114:115], v3 offset:3072
    ds_read_b64_tr_b16 v[116:117], v1 offset:2048
    ds_read_b64_tr_b16 v[118:119], v1 offset:3072
    s_waitcnt vmcnt(10) lgkmcnt(4)
    v_mfma_f32_32x32x16_bf16 v[16:31], v[104:107], v[72:75], v[16:31]
    v_mfma_f32_32x32x16_bf16 v[32:47], v[108:111], v[72:75], v[32:47]
    ds_read_b64_tr_b16 v[104:105], v3 offset:4096
    ds_read_b64_tr_b16 v[106:107], v3 offset:5120
    ds_read_b64_tr_b16 v[108:109], v1 offset:4096
    ds_read_b64_tr_b16 v[110:111], v1 offset:5120
    s_waitcnt vmcnt(9) lgkmcnt(4)
    v_mfma_f32_32x32x16_bf16 v[16:31], v[112:115], v[76:79], v[16:31]
    v_mfma_f32_32x32x16_bf16 v[32:47], v[116:119], v[76:79], v[32:47]
    ds_read_b64_tr_b16 v[112:113], v3 offset:6144
    ds_read_b64_tr_b16 v[114:115], v3 offset:7168
    ds_read_b64_tr_b16 v[116:117], v1 offset:6144
    ds_read_b64_tr_b16 v[118:119], v1 offset:7168
    s_waitcnt vmcnt(8) lgkmcnt(4)
    v_mfma_f32_32x32x16_bf16 v[16:31], v[104:107], v[80:83], v[16:31]
    v_mfma_f32_32x32x16_bf16 v[32:47], v[108:111], v[80:83], v[32:47]
    ds_read_b64_tr_b16 v[104:105], v3 offset:8192
    ds_read_b64_tr_b16 v[106:107], v3 offset:9216
    ds_read_b64_tr_b16 v[108:109], v1 offset:8192
    ds_read_b64_tr_b16 v[110:111], v1 offset:9216
    s_waitcnt vmcnt(7) lgkmcnt(4)
    v_mfma_f32_32x32x16_bf16 v[16:31], v[112:115], v[84:87], v[16:31]
    v_mfma_f32_32x32x16_bf16 v[32:47], v[116:119], v[84:87], v[32:47]
    ds_read_b64_tr_b16 v[112:113], v3 offset:10240
    ds_read_b64_tr_b16 v[114:115], v3 offset:11264
    ds_read_b64_tr_b16 v[116:117], v1 offset:10240
    ds_read_b64_tr_b16 v[118:119], v1 offset:11264
    s_waitcnt vmcnt(6) lgkmcnt(4)
    v_mfma_f32_32x32x16_bf16 v[16:31], v[104:107], v[88:91], v[16:31]
    v_mfma_f32_32x32x16_bf16 v[32:47], v[108:111], v[88:91], v[32:47]
    ds_read_b64_tr_b16 v[104:105], v3 offset:12288
    ds_read_b64_tr_b16 v[106:107], v3 offset:13312
    ds_read_b64_tr_b16 v[108:109], v1 offset:12288
    ds_read_b64_tr_b16 v[110:111], v1 offset:13312
    s_waitcnt vmcnt(5) lgkmcnt(4)
    v_mfma_f32_32x32x16_bf16 v[16:31], v[112:115], v[92:95], v[16:31]
    v_mfma_f32_32x32x16_bf16 v[32:47], v[116:119], v[92:95], v[32:47]
    ds_read_b64_tr_b16 v[112:113], v3 offset:14336
    ds_read_b64_tr_b16 v[114:115], v3 offset:15360
    ds_read_b64_tr_b16 v[116:117], v1 offset:14336
    ds_read_b64_tr_b16 v[118:119], v1 offset:15360
    s_waitcnt vmcnt(4) lgkmcnt(4)
    v_mfma_f32_32x32x16_bf16 v[16:31], v[104:107], v[96:99], v[16:31]
    v_mfma_f32_32x32x16_bf16 v[32:47], v[108:111], v[96:99], v[32:47]
    s_waitcnt vmcnt(3) lgkmcnt(0)
    v_mfma_f32_32x32x16_bf16 v[16:31], v[112:115], v[100:103], v[16:31]
    v_mfma_f32_32x32x16_bf16 v[32:47], v[116:119], v[100:103], v[32:47]
    s_lshl_b32 s48, s36, 13
    s_add_u32 s48, s48, 0x10000
    v_add_u32 v10, s48, v2
    s_nop 12
    ds_write_b128 v10, v[16:19] offset:0
    ds_write_b128 v10, v[20:23] offset:1024
    ds_write_b128 v10, v[24:27] offset:2048
    ds_write_b128 v10, v[28:31] offset:3072
    ds_write_b128 v10, v[32:35] offset:4096
    ds_write_b128 v10, v[36:39] offset:5120
    ds_write_b128 v10, v[40:43] offset:6144
    ds_write_b128 v10, v[44:47] offset:7168
    s_lshl_b32 s48, s42, 13
    s_lshl_b32 s49, s44, 11
    s_add_u32 s48, s48, s49
    s_add_u32 s48, s48, 0x10000
    v_add_u32 v11, s48, v2
    s_waitcnt lgkmcnt(0)
    s_barrier
    ds_read_b128 v[72:75], v11 offset:0
    ds_read_b128 v[76:79], v11 offset:1024
    ds_read_b128 v[80:83], v11 offset:16384
    ds_read_b128 v[84:87], v11 offset:17408
    ds_read_b128 v[88:91], v11 offset:32768
    ds_read_b128 v[92:95], v11 offset:33792
    ds_read_b128 v[96:99], v11 offset:49152
    ds_read_b128 v[100:103], v11 offset:50176
    v_sub_f32 v54, 1.0, v55
    s_waitcnt vmcnt(0) lgkmcnt(0)
    v_add_f32 v72, v72, v80
    v_add_f32 v88, v88, v96
    v_add_f32 v73, v73, v81
    v_add_f32 v89, v89, v97
    v_add_f32 v74, v74, v82
    v_add_f32 v90, v90, v98
    v_add_f32 v75, v75, v83
    v_add_f32 v91, v91, v99
    v_add_f32 v76, v76, v84
    v_add_f32 v92, v92, v100
    v_add_f32 v77, v77, v85
    v_add_f32 v93, v93, v101
    v_add_f32 v78, v78, v86
    v_add_f32 v94, v94, v102
    v_add_f32 v79, v79, v87
    v_add_f32 v95, v95, v103
    v_add_f32 v72, v72, v88
    v_add_f32 v73, v73, v89
    v_add_f32 v74, v74, v90
    v_add_f32 v75, v75, v91
    v_add_f32 v76, v76, v92
    v_add_f32 v77, v77, v93
    v_add_f32 v78, v78, v94
    v_add_f32 v79, v79, v95
    s_cmp_eq_u32 s50, 1
    s_cbranch_scc1 K3_EPI_M
    v_mul_f32 v40, v54, v56
    v_mul_f32 v41, v54, v57
    v_mul_f32 v42, v54, v58
    v_mul_f32 v43, v54, v59
    v_mul_f32 v44, v54, v60
    v_mul_f32 v45, v54, v61
    v_mul_f32 v46, v54, v62
    v_mul_f32 v47, v54, v63
    s_branch K3_EPI2
K3_EPI_M:
    v_mul_f32 v40, v54, v64
    v_mul_f32 v41, v54, v63
    v_mul_f32 v42, v54, v62
    v_mul_f32 v43, v54, v61
    v_mul_f32 v44, v54, v60
    v_mul_f32 v45, v54, v59
    v_mul_f32 v46, v54, v58
    v_mul_f32 v47, v54, v57
K3_EPI2:
    v_fmac_f32 v40, v55, v72
    v_fmac_f32 v41, v55, v73
    v_fmac_f32 v42, v55, v74
    v_fmac_f32 v43, v55, v75
    v_fmac_f32 v44, v55, v76
    v_fmac_f32 v45, v55, v77
    v_fmac_f32 v46, v55, v78
    v_fmac_f32 v47, v55, v79
    v_cvt_pk_bf16_f32 v48, v40, v41
    v_cvt_pk_bf16_f32 v49, v42, v43
    v_cvt_pk_bf16_f32 v50, v44, v45
    v_cvt_pk_bf16_f32 v51, v46, v47
    buffer_store_dwordx4 v[48:51], v4, s[8:11], 0 offen
    s_endpgm

KERNEL_END:
.section .rodata,"a"
.p2align 6
.amdhsa_kernel gated_mix__softmax_full_mha__spectral_fnet__prompt_kernel
  .amdhsa_next_free_vgpr 168
  .amdhsa_next_free_sgpr 96
  .amdhsa_accum_offset 168
  .amdhsa_group_segment_fixed_size 0
  .amdhsa_kernarg_size 96
  .amdhsa_user_sgpr_count 2
  .amdhsa_user_sgpr_kernarg_segment_ptr 1
  .amdhsa_system_sgpr_workgroup_id_x 1
.end_amdhsa_kernel
.text
```
